```python
import torch

def _softmax(x, axis=-1):
    return torch.softmax(x, dim=axis)

def _gelu(x):
    return torch.nn.functional.gelu(x, approximate='tanh')

def _silu(x):
    return torch.nn.functional.silu(x)

def _sigmoid(x):
    return torch.sigmoid(x)

def _layernorm(x, axis=-1, eps=1e-05):
    m = x.mean(dim=axis, keepdim=True)
    v = x.var(dim=axis, keepdim=True, unbiased=False)
    return (x - m) / torch.sqrt(v + eps)

def _scatter_add(tgt, idx, src, axis=0):
    return tgt.clone().index_add_(axis, idx, src)

def _segment_sum(src, seg, n):
    out = torch.zeros((n,) + src.shape[1:], dtype=src.dtype)
    return out.index_add_(0, seg, src)

def _pad(x, pw):
    flat = tuple((v for pair in reversed(pw) for v in pair))
    return torch.nn.functional.pad(x, flat)
kernel_name = 'adaLN_cond__ssm_conv_s4__dense_activation_squared_relu__prompt'

def setup_inputs():

    _w = lambda a: (lambda t: t.to(torch.bfloat16) if t.is_floating_point() else t)(torch.as_tensor(a))

    def _A_setup():
        B, L, D, N = (1, 2048, 512, 128)
        A_re = -(lambda _x: torch.exp(torch.as_tensor(_x)))((lambda *s: torch.randn(*s, dtype=torch.bfloat16) * 3.2)(D, N))
        A_im = torch.pi * (lambda *s: torch.randn(*s, dtype=torch.bfloat16) * 0.1)(D, N)
        B_re = (lambda *s: torch.randn(*s, dtype=torch.bfloat16) * 0.2)(D, N)
        B_im = (lambda *s: torch.randn(*s, dtype=torch.bfloat16) * 0.2)(D, N)
        C_re = (lambda *s: torch.randn(*s, dtype=torch.bfloat16) * 0.2)(D, N)
        C_im = (lambda *s: torch.randn(*s, dtype=torch.bfloat16) * 0.2)(D, N)
        log_dt = (lambda *s: torch.randn(*s, dtype=torch.bfloat16) * 0.1)(D) * 0.5 - 4.0
        Dskip = (lambda *s: torch.randn(*s, dtype=torch.bfloat16) * 0.2)(D)
        return {'u': _w((lambda *s: torch.randn(*s, dtype=torch.bfloat16) * 0.05)(B, L, D)), 'A_re': _w(A_re), 'A_im': _w(A_im), 'B_re': _w(B_re), 'B_im': _w(B_im), 'C_re': _w(C_re), 'C_im': _w(C_im), 'log_dt': _w(log_dt), 'Dskip': _w(Dskip)}
    _A_in = _A_setup()

    def _B_setup():
        B, S, D, F = (1, 2048, 512, 1376)
        return {'x': _w((lambda *s: torch.randn(*s, dtype=torch.bfloat16) * 0.05)(B, S, D)), 'w1': _w((lambda *s: torch.randn(*s, dtype=torch.bfloat16) * 0.05)(D, F)), 'b1': _w((lambda *s: torch.randn(*s, dtype=torch.bfloat16) * 0.4)(F)), 'w2': _w((lambda *s: torch.randn(*s, dtype=torch.bfloat16) * 0.05)(F, D)), 'b2': _w((lambda *s: torch.randn(*s, dtype=torch.bfloat16) * 3.2)(D))}
    _B_in = _B_setup()
    return {'A_u': _A_in['u'], 'A_A_re': _A_in['A_re'], 'A_A_im': _A_in['A_im'], 'A_B_re': _A_in['B_re'], 'A_B_im': _A_in['B_im'], 'A_C_re': _A_in['C_re'], 'A_C_im': _A_in['C_im'], 'A_log_dt': _A_in['log_dt'], 'A_Dskip': _A_in['Dskip'], 'B_x': _B_in['x'], 'B_w1': _B_in['w1'], 'B_b1': _B_in['b1'], 'B_w2': _B_in['w2'], 'B_b2': _B_in['b2'], 'c': _w((lambda *s: torch.randn(*s, dtype=torch.bfloat16) * 0.1)(1, 512) * 8.0), 'w_mod': _w((lambda *s: torch.randn(*s, dtype=torch.bfloat16) * 0.1)(512, 6 * 512) * 512 ** (-0.5) * 8.0)}

def reference(A_u, A_A_re, A_A_im, A_B_re, A_B_im, A_C_re, A_C_im, A_log_dt, A_Dskip, B_x, B_w1, B_b1, B_w2, B_b2, c, w_mod):

    def _A_ref(u, A_re, A_im, B_re, B_im, C_re, C_im, log_dt, Dskip):
        Bsz, L, D = u.shape
        dt = torch.exp(log_dt)[:, None]
        A = A_re + 1j * A_im
        Bc = B_re + 1j * B_im
        Cc = C_re + 1j * C_im
        logdA = dt * A
        dB = dt * Bc
        l = (lambda x, dt: x.to(dt))(torch.arange(L), A_re.dtype)
        P = torch.exp(logdA[:, :, None] * l[None, None, :])
        K = torch.einsum('dn,dnl,dn->dl', Cc, P, dB).real
        L2 = 2 * L
        Kp = _pad(K, ((0, 0), (0, L)))
        up = (lambda x, *d: x.permute(*d))(u, 0, 2, 1)
        up = _pad(up, ((0, 0), (0, 0), (0, L)))
        Kf = (lambda x, axes=(-2, -1): torch.fft.rfft2(x.float(), dim=axes))(Kp[:, None, :], axes=(-2, -1))
        Uf = (lambda x, axes=(-2, -1): torch.fft.rfft2(x.float(), dim=axes))(up[:, :, None, :], axes=(-2, -1))
        Yf = Uf * Kf[None, :, :, :]
        y = (lambda x, s, axes=(-2, -1): torch.fft.irfft2(x, s=s, dim=axes).to(torch.bfloat16))(Yf, (1, L2), axes=(-2, -1))[:, :, 0, :L]
        y = (lambda x, *d: x.permute(*d))(y, 0, 2, 1) + u * Dskip[None, None, :]
        return y

    def _B_ref(x, w1, b1, w2, b2):
        h = torch.einsum('bsd,df->bsf', x, w1) + b1
        zero = torch.zeros_like(h)
        r = torch.where(h > zero, h, zero)
        h = r * r
        out = torch.einsum('bsf,fd->bsd', h, w2) + b2
        return out
    x = A_u
    mod = (_silu(c) @ w_mod).reshape(c.shape[0], 6, 1, -1)
    sa, ca, ga, sb, cb, gb = (mod[:, 0].clone(), mod[:, 1].clone(), mod[:, 2].clone(), mod[:, 3].clone(), mod[:, 4].clone(), mod[:, 5].clone())
    h = _layernorm(x, axis=-1) * (1 + ca) + sa
    x = x + ga * _A_ref(h, A_A_re, A_A_im, A_B_re, A_B_im, A_C_re, A_C_im, A_log_dt, A_Dskip)
    h = _layernorm(x, axis=-1) * (1 + cb) + sb
    x = x + gb * _B_ref(h, B_w1, B_b1, B_w2, B_b2)
    return x
```

```asm
; @launch grid=(256,1,1) block=(512,1,1) lds=163840
.amdgcn_target "amdgcn-amd-amdhsa--gfx950"
.text
.globl adaLN_cond__ssm_conv_s4__dense_activation_squared_relu__prompt_kernel
.p2align 8
.type adaLN_cond__ssm_conv_s4__dense_activation_squared_relu__prompt_kernel,@function
adaLN_cond__ssm_conv_s4__dense_activation_squared_relu__prompt_kernel:
    s_cmp_ge_u32 s2, 256
    s_cbranch_scc1 L_end
    s_load_dwordx16 s[36:51], s[0:1], 0
    s_load_dwordx2 s[72:73], s[0:1], 144
    s_load_dwordx16 s[52:67], s[0:1], 64
    s_load_dwordx4 s[68:71], s[0:1], 128
    s_getpc_b64 s[74:75]
L_pcref:
    s_sub_u32 s74, s74, L_pcref-adaLN_cond__ssm_conv_s4__dense_activation_squared_relu__prompt_kernel
    s_subb_u32 s75, s75, 0
    s_lshr_b32 s76, s2, 3
    s_lshl_b32 s77, s76, 13
    v_lshlrev_b32 v20, 7, v0
    v_add_u32 v20, s77, v20
    v_min_u32 v20, L_codeend-adaLN_cond__ssm_conv_s4__dense_activation_squared_relu__prompt_kernel-4, v20
    s_cmp_ge_u32 s76, 4
    s_cbranch_scc1 L_nocpf
    v_cmp_gt_u32 vcc, 64, v0
    s_and_saveexec_b64 s[76:77], vcc
    s_cbranch_execz L_cpfx
    global_load_dword v21, v20, s[74:75]
L_cpfx:
    s_mov_b64 exec, s[76:77]
L_nocpf:
    v_lshrrev_b32 v2, 6, v0
    v_and_b32 v1, 63, v0
    s_and_b32 s6, s2, 7
    v_readfirstlane_b32 s3, v2
    s_lshr_b32 s7, s2, 3
    s_lshl_b32 s5, s6, 5
    s_add_u32 s5, s5, s7
    s_cmp_lt_u32 s3, 4
    s_cbranch_scc1 L_M_P0
L_H_P1:
    s_setprio 3
    s_sub_u32 s28, s3, 4
    v_and_b32 v2, 1, v1
    v_lshlrev_b32 v2, 12, v2
    v_lshrrev_b32 v3, 1, v1
    s_lshl_b32 s29, s28, 6
    v_add_u32 v3, s29, v3
    v_lshlrev_b32 v3, 2, v3
    v_add_u32 v2, v2, v3
    s_lshl_b32 s30, s2, 13
    s_mov_b32 s18, 2097152
    s_mov_b32 s19, 0x20000
    s_waitcnt lgkmcnt(0)
    s_mov_b32 s16, s36
    s_and_b32 s17, s37, 0xffff
    buffer_load_dword v10, v2, s[16:19], s30 offen offset:0
    buffer_load_dword v11, v2, s[16:19], s30 offen offset:1024
    buffer_load_dword v12, v2, s[16:19], s30 offen offset:2048
    buffer_load_dword v13, v2, s[16:19], s30 offen offset:3072
    buffer_load_dword v14, v2, s[16:19], s30 offen offset:128
    buffer_load_dword v15, v2, s[16:19], s30 offen offset:1152
    buffer_load_dword v16, v2, s[16:19], s30 offen offset:2176
    buffer_load_dword v17, v2, s[16:19], s30 offen offset:3200
    s_mov_b32 s8, s72
    s_and_b32 s9, s73, 0xffff
    s_mov_b32 s10, 268435456
    s_mov_b32 s11, 0x20000
    v_mov_b32 v253, 0
    buffer_load_dword v255, v253, s[8:11], 0 offen sc1
    s_lshl_b32 s32, s28, 11
    s_add_u32 s32, s32, s30
    v_lshlrev_b32 v3, 4, v1
    buffer_load_dwordx4 v[26:29], v3, s[16:19], s32 offen
    buffer_load_dwordx4 v[30:33], v3, s[16:19], s32 offen offset:1024
    s_mov_b32 s24, s60
    s_and_b32 s25, s61, 0xffff
    s_mov_b32 s26, 1409024
    s_mov_b32 s27, 0x20000
    s_lshl_b32 s74, s28, 8
    s_add_u32 s74, s74, s2
    s_mul_hi_u32 s75, s74, 49941481
    s_mul_i32 s76, s75, 86
    s_sub_u32 s76, s74, s76
    s_lshl_b32 s76, s76, 14
    s_lshl_b32 s75, s75, 6
    s_add_u32 s76, s76, s75
    v_lshrrev_b32 v69, 2, v1
    v_lshlrev_b32 v69, 10, v69
    v_and_b32 v70, 3, v1
    v_lshlrev_b32 v70, 4, v70
    v_add_u32 v69, v69, v70
    buffer_load_dwordx4 v[168:171], v69, s[24:27], s76 offen
    s_add_u32 s74, s74, 1024
    s_mul_hi_u32 s75, s74, 49941481
    s_mul_i32 s76, s75, 86
    s_sub_u32 s76, s74, s76
    s_lshl_b32 s76, s76, 14
    s_lshl_b32 s75, s75, 6
    s_add_u32 s76, s76, s75
    buffer_load_dwordx4 v[172:175], v69, s[24:27], s76 offen
    s_cmp_eq_u32 s28, 0
    s_cbranch_scc1 L_tn_3
    s_cmp_eq_u32 s28, 3
    s_cbranch_scc1 L_t7_1
    s_lshl_b32 s33, s2, 1
    s_add_u32 s33, s33, s28
    s_sub_u32 s33, s33, 1
    s_lshr_b32 s35, s33, 5
    s_and_b32 s33, s33, 31
    s_add_u32 s33, s33, 16
    s_branch L_tj_2
L_t7_1:
    s_and_b32 s33, s2, 15
    s_lshr_b32 s35, s2, 4
L_tj_2:
    s_mov_b32 s20, s66
    s_and_b32 s21, s67, 0xffff
    s_mov_b32 s22, 3145728
    s_mov_b32 s23, 0x20000
    s_mov_b32 s24, s64
    s_and_b32 s25, s65, 0xffff
    s_mov_b32 s26, 1024
    s_mov_b32 s27, 0x20000
    v_lshrrev_b32 v4, 3, v1
    s_lshl_b32 s34, s35, 5
    v_add_u32 v4, s34, v4
    v_mul_u32_u24 v5, 6144, v4
    v_and_b32 v6, 7, v1
    v_lshlrev_b32 v6, 4, v6
    v_add_u32 v5, v5, v6
    v_lshlrev_b32 v4, 1, v4
    s_lshl_b32 s34, s33, 7
    buffer_load_dwordx4 v[36:39], v5, s[20:23], s34 offen
    s_add_u32 s34, s34, 49152
    buffer_load_dwordx4 v[40:43], v5, s[20:23], s34 offen
    s_add_u32 s34, s34, 49152
    buffer_load_dwordx4 v[44:47], v5, s[20:23], s34 offen
    s_add_u32 s34, s34, 49152
    buffer_load_dwordx4 v[48:51], v5, s[20:23], s34 offen
    buffer_load_ushort v52, v4, s[24:27], 0 offen offset:0
    buffer_load_ushort v53, v4, s[24:27], 0 offen offset:16
    buffer_load_ushort v54, v4, s[24:27], 0 offen offset:32
    buffer_load_ushort v55, v4, s[24:27], 0 offen offset:48
L_tn_3:
    v_mov_b32 v8, 0
    v_mov_b32 v9, 0
    v_mov_b32 v34, 156416
    ds_write_b64 v34, v[8:9] offset:0
    ds_write_b64 v34, v[8:9] offset:8
    ds_write_b64 v34, v[8:9] offset:16
    ds_write_b64 v34, v[8:9] offset:24
    ds_write_b64 v34, v[8:9] offset:32
    ds_write_b64 v34, v[8:9] offset:40
    ds_write_b64 v34, v[8:9] offset:48
    ds_write_b64 v34, v[8:9] offset:56
    s_waitcnt lgkmcnt(0)
    s_barrier
    s_cmp_lg_u32 s28, 0
    s_cbranch_scc1 L_hasmod_4
    s_waitcnt vmcnt(4)
    s_branch L_w_5
L_hasmod_4:
    s_waitcnt vmcnt(12)
L_w_5:
    v_lshlrev_b32 v2, 4, v1
    s_lshl_b32 s30, s2, 13
    s_lshl_b32 s31, s28, 11
    s_add_u32 s30, s30, s31
    s_add_u32 s30, s30, 1114112
    buffer_store_dwordx4 v[10:13], v2, s[8:11], s30 offen offset:0 sc1
    buffer_store_dwordx4 v[14:17], v2, s[8:11], s30 offen offset:1024 sc1
    v_readfirstlane_b32 s4, v255
    s_add_u32 s4, s4, 2654435769
    s_cmp_eq_u32 s28, 0
    s_cbranch_scc1 L_no56_6
    s_branch L_w7_8
L_w7_8:
    s_waitcnt vmcnt(12)
    s_branch L_wj_9
L_no56_6:
    s_waitcnt vmcnt(4)
L_wj_9:
    v_lshlrev_b32 v60, 16, v26
    v_and_b32 v61, 0xffff0000, v26
    v_lshlrev_b32 v62, 16, v27
    v_and_b32 v63, 0xffff0000, v27
    v_lshlrev_b32 v64, 16, v28
    v_and_b32 v65, 0xffff0000, v28
    v_lshlrev_b32 v66, 16, v29
    v_and_b32 v67, 0xffff0000, v29
    v_lshlrev_b32 v68, 16, v30
    v_and_b32 v69, 0xffff0000, v30
    v_lshlrev_b32 v70, 16, v31
    v_and_b32 v71, 0xffff0000, v31
    v_lshlrev_b32 v72, 16, v32
    v_and_b32 v73, 0xffff0000, v32
    v_lshlrev_b32 v74, 16, v33
    v_and_b32 v75, 0xffff0000, v33
    v_add_f32 v84, v60, v61
    v_add_f32 v85, v68, v69
    v_add_f32 v84, v84, v62
    v_add_f32 v85, v85, v70
    v_add_f32 v84, v84, v63
    v_add_f32 v85, v85, v71
    v_add_f32 v84, v84, v64
    v_add_f32 v85, v85, v72
    v_add_f32 v84, v84, v65
    v_add_f32 v85, v85, v73
    v_add_f32 v84, v84, v66
    v_add_f32 v85, v85, v74
    v_add_f32 v84, v84, v67
    v_add_f32 v85, v85, v75
    s_nop 0
    v_add_f32_dpp v84, v84, v84 row_shr:1 row_mask:0xf bank_mask:0xf
    v_add_f32_dpp v85, v85, v85 row_shr:1 row_mask:0xf bank_mask:0xf
    s_nop 0
    v_add_f32_dpp v84, v84, v84 row_shr:2 row_mask:0xf bank_mask:0xf
    v_add_f32_dpp v85, v85, v85 row_shr:2 row_mask:0xf bank_mask:0xf
    s_nop 0
    v_add_f32_dpp v84, v84, v84 row_shr:4 row_mask:0xf bank_mask:0xf
    v_add_f32_dpp v85, v85, v85 row_shr:4 row_mask:0xf bank_mask:0xf
    s_nop 0
    v_add_f32_dpp v84, v84, v84 row_shr:8 row_mask:0xf bank_mask:0xf
    v_add_f32_dpp v85, v85, v85 row_shr:8 row_mask:0xf bank_mask:0xf
    s_nop 0
    v_add_f32_dpp v84, v84, v84 row_bcast:15 row_mask:0xa bank_mask:0xf
    v_add_f32_dpp v85, v85, v85 row_bcast:15 row_mask:0xa bank_mask:0xf
    s_nop 0
    v_add_f32_dpp v84, v84, v84 row_bcast:31 row_mask:0xc bank_mask:0xf
    v_add_f32_dpp v85, v85, v85 row_bcast:31 row_mask:0xc bank_mask:0xf
    v_readlane_b32 s74, v84, 63
    v_readlane_b32 s75, v85, 63
    s_mov_b32 s76, 0x3b000000
    v_mov_b32 v84, s74
    v_mov_b32 v85, s75
    v_mul_f32 v84, s76, v84
    v_mul_f32 v85, s76, v85
    v_sub_f32 v60, v60, v84
    v_sub_f32 v68, v68, v85
    v_sub_f32 v61, v61, v84
    v_sub_f32 v69, v69, v85
    v_sub_f32 v62, v62, v84
    v_sub_f32 v70, v70, v85
    v_sub_f32 v63, v63, v84
    v_sub_f32 v71, v71, v85
    v_sub_f32 v64, v64, v84
    v_sub_f32 v72, v72, v85
    v_sub_f32 v65, v65, v84
    v_sub_f32 v73, v73, v85
    v_sub_f32 v66, v66, v84
    v_sub_f32 v74, v74, v85
    v_sub_f32 v67, v67, v84
    v_sub_f32 v75, v75, v85
    v_mul_f32 v86, v60, v60
    v_mul_f32 v87, v68, v68
    v_fmac_f32 v86, v61, v61
    v_fmac_f32 v87, v69, v69
    v_fmac_f32 v86, v62, v62
    v_fmac_f32 v87, v70, v70
    v_fmac_f32 v86, v63, v63
    v_fmac_f32 v87, v71, v71
    v_fmac_f32 v86, v64, v64
    v_fmac_f32 v87, v72, v72
    v_fmac_f32 v86, v65, v65
    v_fmac_f32 v87, v73, v73
    v_fmac_f32 v86, v66, v66
    v_fmac_f32 v87, v74, v74
    v_fmac_f32 v86, v67, v67
    v_fmac_f32 v87, v75, v75
    s_nop 0
    v_add_f32_dpp v86, v86, v86 row_shr:1 row_mask:0xf bank_mask:0xf
    v_add_f32_dpp v87, v87, v87 row_shr:1 row_mask:0xf bank_mask:0xf
    s_nop 0
    v_add_f32_dpp v86, v86, v86 row_shr:2 row_mask:0xf bank_mask:0xf
    v_add_f32_dpp v87, v87, v87 row_shr:2 row_mask:0xf bank_mask:0xf
    s_nop 0
    v_add_f32_dpp v86, v86, v86 row_shr:4 row_mask:0xf bank_mask:0xf
    v_add_f32_dpp v87, v87, v87 row_shr:4 row_mask:0xf bank_mask:0xf
    s_nop 0
    v_add_f32_dpp v86, v86, v86 row_shr:8 row_mask:0xf bank_mask:0xf
    v_add_f32_dpp v87, v87, v87 row_shr:8 row_mask:0xf bank_mask:0xf
    s_nop 0
    v_add_f32_dpp v86, v86, v86 row_bcast:15 row_mask:0xa bank_mask:0xf
    v_add_f32_dpp v87, v87, v87 row_bcast:15 row_mask:0xa bank_mask:0xf
    s_nop 0
    v_add_f32_dpp v86, v86, v86 row_bcast:31 row_mask:0xc bank_mask:0xf
    v_add_f32_dpp v87, v87, v87 row_bcast:31 row_mask:0xc bank_mask:0xf
    v_mul_f32 v86, s76, v86
    v_mul_f32 v87, s76, v87
    v_cvt_pk_bf16_f32 v88, v86, v87
    v_lshlrev_b32 v86, 16, v88
    v_and_b32 v87, 0xffff0000, v88
    v_add_f32 v86, 0x3727c5ac, v86
    v_add_f32 v87, 0x3727c5ac, v87
    v_cvt_pk_bf16_f32 v88, v86, v87
    v_lshlrev_b32 v86, 16, v88
    v_and_b32 v87, 0xffff0000, v88
    v_sqrt_f32 v86, v86
    v_sqrt_f32 v87, v87
    v_cvt_pk_bf16_f32 v90, v84, v86
    v_cvt_pk_bf16_f32 v92, v85, v87
    v_mov_b32 v91, s4
    v_mov_b32 v93, s4
    s_lshl_b32 s30, s2, 6
    s_lshl_b32 s31, s28, 4
    s_add_u32 s30, s30, s31
    s_add_u32 s30, s30, 16384
    v_mov_b32 v94, 0
    s_cmp_eq_u32 s28, 9
    s_cbranch_scc1 L_x8_10
    s_cmp_eq_u32 s28, 9
    s_cbranch_scc1 L_x8_10
    s_waitcnt vmcnt(0)
    s_branch L_x0_11
L_x8_10:
    s_waitcnt vmcnt(8)
L_x0_11:
    s_mov_b32 exec_lo, 0
    s_mov_b32 exec_hi, 0x80000000
    buffer_store_dwordx4 v[90:93], v94, s[8:11], s30 offen sc1
    s_mov_b64 exec, -1
    s_cmp_eq_u32 s28, 0
    s_cbranch_scc1 L_nomodc_12
    s_waitcnt vmcnt(1)
    v_lshlrev_b32 v52, 16, v52
    v_mul_f32 v56, 0xbfb8aa3b, v52
    v_exp_f32 v56, v56
    s_nop 0
    v_add_f32 v56, 1.0, v56
    v_rcp_f32 v56, v56
    s_nop 0
    v_mul_f32 v56, v52, v56
    v_cvt_pk_bf16_f32 v100, v56, 0
    v_lshlrev_b32 v101, 16, v100
    v_lshlrev_b32 v53, 16, v53
    v_mul_f32 v56, 0xbfb8aa3b, v53
    v_exp_f32 v56, v56
    s_nop 0
    v_add_f32 v56, 1.0, v56
    v_rcp_f32 v56, v56
    s_nop 0
    v_mul_f32 v56, v53, v56
    v_cvt_pk_bf16_f32 v102, v56, 0
    v_lshlrev_b32 v103, 16, v102
    v_lshlrev_b32 v54, 16, v54
    v_mul_f32 v56, 0xbfb8aa3b, v54
    v_exp_f32 v56, v56
    s_nop 0
    v_add_f32 v56, 1.0, v56
    v_rcp_f32 v56, v56
    s_nop 0
    v_mul_f32 v56, v54, v56
    v_cvt_pk_bf16_f32 v104, v56, 0
    v_lshlrev_b32 v105, 16, v104
    v_lshlrev_b32 v55, 16, v55
    v_mul_f32 v56, 0xbfb8aa3b, v55
    v_exp_f32 v56, v56
    s_nop 0
    v_add_f32 v56, 1.0, v56
    v_rcp_f32 v56, v56
    s_nop 0
    v_mul_f32 v56, v55, v56
    v_cvt_pk_bf16_f32 v106, v56, 0
    v_lshlrev_b32 v107, 16, v106
    v_mov_b32 v110, 0
    v_mov_b32 v111, 0
    v_mov_b32 v112, 0
    v_mov_b32 v113, 0
    v_mov_b32 v114, 0
    v_mov_b32 v115, 0
    v_mov_b32 v116, 0
    v_mov_b32 v117, 0
    v_dot2c_f32_bf16 v110, v36, v100
    v_dot2c_f32_bf16 v111, v36, v101
    v_dot2c_f32_bf16 v112, v37, v100
    v_dot2c_f32_bf16 v113, v37, v101
    v_dot2c_f32_bf16 v114, v38, v100
    v_dot2c_f32_bf16 v115, v38, v101
    v_dot2c_f32_bf16 v116, v39, v100
    v_dot2c_f32_bf16 v117, v39, v101
    v_dot2c_f32_bf16 v110, v40, v102
    v_dot2c_f32_bf16 v111, v40, v103
    v_dot2c_f32_bf16 v112, v41, v102
    v_dot2c_f32_bf16 v113, v41, v103
    v_dot2c_f32_bf16 v114, v42, v102
    v_dot2c_f32_bf16 v115, v42, v103
    v_dot2c_f32_bf16 v116, v43, v102
    v_dot2c_f32_bf16 v117, v43, v103
    v_dot2c_f32_bf16 v110, v44, v104
    v_dot2c_f32_bf16 v111, v44, v105
    v_dot2c_f32_bf16 v112, v45, v104
    v_dot2c_f32_bf16 v113, v45, v105
    v_dot2c_f32_bf16 v114, v46, v104
    v_dot2c_f32_bf16 v115, v46, v105
    v_dot2c_f32_bf16 v116, v47, v104
    v_dot2c_f32_bf16 v117, v47, v105
    v_dot2c_f32_bf16 v110, v48, v106
    v_dot2c_f32_bf16 v111, v48, v107
    v_dot2c_f32_bf16 v112, v49, v106
    v_dot2c_f32_bf16 v113, v49, v107
    v_dot2c_f32_bf16 v114, v50, v106
    v_dot2c_f32_bf16 v115, v50, v107
    v_dot2c_f32_bf16 v116, v51, v106
    v_dot2c_f32_bf16 v117, v51, v107
    s_nop 1
    v_permlane32_swap_b32 v110, v111
    v_permlane32_swap_b32 v112, v113
    v_permlane32_swap_b32 v114, v115
    v_permlane32_swap_b32 v116, v117
    v_add_f32 v110, v110, v111
    v_add_f32 v112, v112, v113
    v_add_f32 v114, v114, v115
    v_add_f32 v116, v116, v117
    s_nop 1
    v_permlane16_swap_b32 v110, v112
    v_permlane16_swap_b32 v114, v116
    v_add_f32 v110, v110, v112
    v_add_f32 v114, v114, v116
    s_nop 1
    v_add_f32_dpp v110, v110, v110 row_ror:8 row_mask:0xf bank_mask:0xf
    v_add_f32_dpp v114, v114, v114 row_ror:8 row_mask:0xf bank_mask:0xf
    v_bfe_u32 v6, v1, 3, 1
    v_cmp_eq_u32 vcc, 1, v6
    s_nop 1
    v_cndmask_b32 v118, v110, v114, vcc
    v_mov_b32 v119, s4
    v_and_b32 v7, 7, v1
    v_lshlrev_b32 v7, 3, v7
    v_lshlrev_b32 v6, 2, v6
    v_bfe_u32 v8, v1, 4, 1
    v_lshlrev_b32 v8, 1, v8
    v_lshrrev_b32 v9, 5, v1
    v_add3_u32 v7, v7, v6, v8
    v_add_u32 v7, v7, v9
    v_lshlrev_b32 v7, 3, v7
    s_mul_i32 s30, s35, 24576
    s_lshl_b32 s31, s33, 9
    s_add_u32 s30, s30, s31
    s_add_u32 s30, s30, 131072
    buffer_store_dwordx2 v[118:119], v7, s[8:11], s30 offen sc1
L_nomodc_12:
    s_mov_b32 s16, s56
    s_and_b32 s17, s57, 0xffff
    s_mov_b32 s18, 1409024
    s_mov_b32 s19, 0x20000
    s_lshr_b32 s29, s28, 1
    s_lshl_b32 s30, s5, 1
    s_add_u32 s30, s30, s29
    s_mul_i32 s31, s30, 2752
    s_and_b32 s32, s28, 1
    s_mul_i32 s32, s32, 1376
    s_add_u32 s31, s31, s32
    v_lshlrev_b32 v68, 4, v1
    buffer_load_dwordx4 v[160:163], v68, s[16:19], s31 offen
    buffer_load_dwordx4 v[164:167], v68, s[16:19], s31 offen offset:1024
    s_sub_u32 s28, s3, 4
    s_lshl_b32 s33, s28, 8
    s_add_u32 s33, s33, s2
    s_lshl_b32 s34, s28, 10
    s_add_u32 s34, s34, 156928
    v_lshlrev_b32 v4, 4, v1
    v_add_u32 v4, s34, v4
    v_lshrrev_b32 v7, 5, v1
    v_lshlrev_b32 v7, 2, v7
    v_bfe_u32 v8, v1, 2, 2
    v_add_u32 v7, v7, v8
    v_lshlrev_b32 v7, 6, v7
    v_bfe_u32 v8, v1, 4, 1
    v_lshlrev_b32 v8, 5, v8
    v_and_b32 v9, 3, v1
    v_lshlrev_b32 v9, 3, v9
    v_add3_u32 v7, v7, v8, v9
    v_add_u32 v7, s34, v7
    v_lshlrev_b32 v8, 4, v1
    s_lshl_b32 s35, s33, 10
    s_add_u32 s35, s35, 7340032
    ds_write_b128 v4, v[168:171]
    s_waitcnt lgkmcnt(0)
    ds_read_b64_tr_b16 v[28:29], v7
    ds_read_b64_tr_b16 v[30:31], v7 offset:512
    s_waitcnt lgkmcnt(0)
    buffer_store_dwordx4 v[28:31], v8, s[8:11], s35 offen sc1
    s_add_u32 s74, s33, 1024
    s_cmp_ge_u32 s74, 1376
    s_cbranch_scc1 L_now2_14
    s_add_u32 s35, s35, 1048576
    ds_write_b128 v4, v[172:175]
    s_waitcnt lgkmcnt(0)
    ds_read_b64_tr_b16 v[32:33], v7
    ds_read_b64_tr_b16 v[34:35], v7 offset:512
    s_waitcnt lgkmcnt(0)
    buffer_store_dwordx4 v[32:35], v8, s[8:11], s35 offen sc1
L_now2_14:
    s_mov_b32 s99, 100000
    v_lshrrev_b32 v2, 1, v1
    s_lshl_b32 s29, s28, 6
    v_add_u32 v2, s29, v2
    v_and_b32 v3, 1, v1
    v_lshlrev_b32 v4, 13, v2
    v_lshlrev_b32 v5, 4, v3
    v_add_u32 v4, v4, v5
    s_lshl_b32 s33, s5, 5
    s_add_u32 s33, s33, 1114112
    v_lshlrev_b32 v6, 6, v2
    v_lshlrev_b32 v5, 5, v3
    v_add_u32 v6, v6, v5
    v_and_b32 v7, 15, v1
    v_mul_u32_u24 v7, 24576, v7
    v_lshrrev_b32 v8, 4, v1
    v_lshlrev_b32 v9, 12, v8
    v_add_u32 v70, v7, v9
    v_and_b32 v9, 0x1000, v9
    v_add_u32 v7, v7, v9
    s_lshl_b32 s31, s5, 4
    s_add_u32 s31, s31, 131072
    s_add_u32 s30, s31, 8192
    s_waitcnt vmcnt(0)
    v_mov_b32 v71, v7
    v_mov_b32 v72, v8
    v_mov_b32 v73, v9
    v_mov_b32 v74, v2
    v_mov_b32 v75, v3
    s_mov_b32 s96, s30
    v_mov_b32 v7, 1
    v_mov_b32 v8, 156416
    s_waitcnt lgkmcnt(0)
    s_mov_b64 exec, 1
    ds_add_rtn_u32 v9, v8, v7
    s_mov_b64 exec, -1
    s_waitcnt lgkmcnt(0)
    v_readfirstlane_b32 s30, v9
    s_cmp_eq_u32 s30, 3
    s_cbranch_scc0 L_nof1w_17
    s_lshl_b32 s30, s2, 4
    s_add_u32 s30, s30, 557056
    v_mov_b32 v2, s4
    v_mov_b32 v3, 0
    s_mov_b64 exec, 1
    buffer_store_dword v2, v3, s[8:11], s30 offen sc1
    s_mov_b64 exec, -1
L_nof1w_17:
    v_mov_b32 v7, v71
    v_mov_b32 v8, v72
    v_mov_b32 v9, v73
    v_mov_b32 v2, v74
    v_mov_b32 v3, v75
    s_mov_b32 s30, s96
    s_sleep 4
L_pollx_15:
    s_mov_b32 s32, 16384
    buffer_load_dwordx4 v[26:29], v6, s[8:11], s32 offen offset:0 sc1
    buffer_load_dwordx4 v[30:33], v6, s[8:11], s32 offen offset:16 sc1
    buffer_load_dwordx4 v[34:37], v6, s[8:11], s32 offen offset:2048 sc1
    buffer_load_dwordx4 v[38:41], v6, s[8:11], s32 offen offset:2064 sc1
    buffer_load_dwordx4 v[42:45], v7, s[8:11], s31 offen sc1
    buffer_load_dwordx4 v[128:131], v70, s[8:11], s30 offen sc1
    s_waitcnt vmcnt(0)
    v_xor_b32 v250, s4, v27
    v_xor_b32 v251, s4, v29
    v_xor_b32 v252, s4, v31
    v_or3_b32 v250, v250, v251, v252
    v_xor_b32 v251, s4, v33
    v_xor_b32 v252, s4, v35
    v_or3_b32 v250, v250, v251, v252
    v_xor_b32 v251, s4, v37
    v_xor_b32 v252, s4, v39
    v_or3_b32 v250, v250, v251, v252
    v_xor_b32 v251, s4, v41
    v_xor_b32 v252, s4, v43
    v_or3_b32 v250, v250, v251, v252
    v_xor_b32 v251, s4, v45
    v_xor_b32 v252, s4, v129
    v_or3_b32 v250, v250, v251, v252
    v_xor_b32 v251, s4, v131
    v_or_b32 v250, v250, v251
    v_cmp_ne_u32 vcc, 0, v250
    s_cbranch_vccz L_okx_16
    s_sub_u32 s99, s99, 1
    s_cmp_eq_u32 s99, 0
    s_cbranch_scc1 L_okx_16
    s_sleep 1
    s_branch L_pollx_15
L_okx_16:
    s_mov_b32 s32, s33
    buffer_load_dwordx4 v[10:13], v4, s[8:11], s32 offen
    s_add_u32 s32, s32, 262144
    buffer_load_dwordx4 v[14:17], v4, s[8:11], s32 offen
    v_add_f32_dpp v128, v128, v128 row_shr:1 row_mask:0xf bank_mask:0xf
    v_add_f32_dpp v130, v130, v130 row_shr:1 row_mask:0xf bank_mask:0xf
    s_nop 0
    v_add_f32_dpp v128, v128, v128 row_shr:2 row_mask:0xf bank_mask:0xf
    v_add_f32_dpp v130, v130, v130 row_shr:2 row_mask:0xf bank_mask:0xf
    s_nop 0
    v_add_f32_dpp v128, v128, v128 row_shr:4 row_mask:0xf bank_mask:0xf
    v_add_f32_dpp v130, v130, v130 row_shr:4 row_mask:0xf bank_mask:0xf
    s_nop 0
    v_add_f32_dpp v128, v128, v128 row_shr:8 row_mask:0xf bank_mask:0xf
    v_add_f32_dpp v130, v130, v130 row_shr:8 row_mask:0xf bank_mask:0xf
    v_cvt_pk_bf16_f32 v206, v128, v130
    s_nop 0
    v_readlane_b32 s74, v206, 15
    v_readlane_b32 s75, v206, 31
    v_readlane_b32 s76, v206, 47
    v_readlane_b32 s77, v206, 63
    s_lshl_b32 s32, s76, 16
    s_and_b32 s33, s76, 0xffff0000
    v_add_f32 v180, s32, 1.0
    v_add_f32 v181, s33, 1.0
    v_cvt_pk_bf16_f32 v182, v180, v181
    v_lshlrev_b32 v180, 16, v182
    v_and_b32 v181, 0xffff0000, v182
    v_mov_b32 v183, 0x21800000
    v_cmp_eq_f32 vcc, 0, v180
    s_nop 1
    v_cndmask_b32 v180, v180, v183, vcc
    v_cmp_eq_f32 vcc, 0, v181
    s_nop 1
    v_cndmask_b32 v181, v181, v183, vcc
    s_lshr_b32 s29, s28, 1
    s_cmp_eq_u32 s29, 0
    s_cselect_b64 s[32:33], -1, 0
    v_cndmask_b32 v186, v181, v180, s[32:33]
    v_lshlrev_b32 v190, 16, v160
    v_and_b32 v191, 0xffff0000, v160
    v_mul_f32 v190, v190, v186
    v_mul_f32 v191, v191, v186
    v_cvt_pk_bf16_f32 v160, v190, v191
    v_lshlrev_b32 v190, 16, v161
    v_and_b32 v191, 0xffff0000, v161
    v_mul_f32 v190, v190, v186
    v_mul_f32 v191, v191, v186
    v_cvt_pk_bf16_f32 v161, v190, v191
    v_lshlrev_b32 v190, 16, v162
    v_and_b32 v191, 0xffff0000, v162
    v_mul_f32 v190, v190, v186
    v_mul_f32 v191, v191, v186
    v_cvt_pk_bf16_f32 v162, v190, v191
    v_lshlrev_b32 v190, 16, v163
    v_and_b32 v191, 0xffff0000, v163
    v_mul_f32 v190, v190, v186
    v_mul_f32 v191, v191, v186
    v_cvt_pk_bf16_f32 v163, v190, v191
    v_lshlrev_b32 v190, 16, v164
    v_and_b32 v191, 0xffff0000, v164
    v_mul_f32 v190, v190, v186
    v_mul_f32 v191, v191, v186
    v_cvt_pk_bf16_f32 v164, v190, v191
    v_lshlrev_b32 v190, 16, v165
    v_and_b32 v191, 0xffff0000, v165
    v_mul_f32 v190, v190, v186
    v_mul_f32 v191, v191, v186
    v_cvt_pk_bf16_f32 v165, v190, v191
    v_lshlrev_b32 v190, 16, v166
    v_and_b32 v191, 0xffff0000, v166
    v_mul_f32 v190, v190, v186
    v_mul_f32 v191, v191, v186
    v_cvt_pk_bf16_f32 v166, v190, v191
    v_lshlrev_b32 v190, 16, v167
    v_and_b32 v191, 0xffff0000, v167
    v_mul_f32 v190, v190, v186
    v_mul_f32 v191, v191, v186
    v_cvt_pk_bf16_f32 v167, v190, v191
    s_lshl_b32 s30, s5, 1
    s_add_u32 s30, s30, s29
    s_mul_i32 s31, s30, 192
    s_add_u32 s31, s31, 5242880
    s_and_b32 s32, s28, 1
    s_mul_i32 s32, s32, 86
    v_add_u32 v210, s32, v1
    v_add_u32 v215, 64, v210
    v_mul_u32_u24 v216, 5462, v210
    v_lshrrev_b32 v216, 16, v216
    v_mul_u32_u24 v217, 12, v216
    v_sub_u32 v217, v210, v217
    v_mul_u32_u24 v216, 98304, v216
    v_lshlrev_b32 v217, 4, v217
    v_add_u32 v210, v216, v217
    v_mul_u32_u24 v216, 5462, v215
    v_lshrrev_b32 v216, 16, v216
    v_mul_u32_u24 v217, 12, v216
    v_sub_u32 v217, v215, v217
    v_mul_u32_u24 v216, 98304, v216
    v_lshlrev_b32 v217, 4, v217
    v_add_u32 v215, v216, v217
    buffer_store_dwordx4 v[160:163], v210, s[8:11], s31 offen sc1
    s_mov_b64 exec, 0x3fffff
    buffer_store_dwordx4 v[164:167], v215, s[8:11], s31 offen sc1
    s_mov_b64 exec, -1
    s_cmp_lg_u32 s28, 0
    s_cbranch_scc1 L_notw4_18
    s_lshl_b32 s32, s75, 16
    s_and_b32 s33, s75, 0xffff0000
    v_rcp_f32 v184, v180
    v_rcp_f32 v185, v181
    v_mov_b32 v187, s32
    v_mov_b32 v188, s33
    v_mul_f32 v189, v187, v184
    v_mul_f32 v190, v188, v185
    v_fma_f32 v191, -v189, v180, v187
    v_fma_f32 v192, -v190, v181, v188
    v_fmac_f32 v189, v191, v184
    v_fmac_f32 v190, v192, v185
    v_cvt_pk_bf16_f32 v193, v189, v190
    v_lshlrev_b32 v191, 16, v193
    v_and_b32 v192, 0xffff0000, v193
    v_sub_f32 v189, v189, v191
    v_sub_f32 v190, v190, v192
    v_cvt_pk_bf16_f32 v194, v189, v190
    s_mov_b32 s32, 0x05040100
    s_mov_b32 s33, 0x07060302
    v_perm_b32 v196, v194, v193, s32
    v_perm_b32 v197, v194, v193, s33
    s_lshl_b32 s32, s77, 16
    s_and_b32 s33, s77, 0xffff0000
    v_mov_b32 v198, s32
    v_mov_b32 v199, s33
    s_lshl_b32 s32, s74, 16
    s_and_b32 s33, s74, 0xffff0000
    v_mov_b32 v200, s32
    v_mov_b32 v201, s33
    v_mov_b32 v211, 0
    v_mov_b32 v212, 156480
    s_lshl_b32 s30, s5, 3
    s_add_u32 s31, s30, 528384
    s_add_u32 s30, s30, 524288
    s_mov_b64 exec, 1
    buffer_store_dwordx2 v[196:197], v211, s[8:11], s30 offen sc1
    buffer_store_dwordx2 v[198:199], v211, s[8:11], s31 offen sc1
    ds_write_b64 v212, v[200:201]
    s_mov_b64 exec, -1
L_notw4_18:
    v_add_f32_dpp v42, v42, v42 row_shr:1 row_mask:0xf bank_mask:0xf
    v_add_f32_dpp v44, v44, v44 row_shr:1 row_mask:0xf bank_mask:0xf
    s_nop 0
    v_add_f32_dpp v42, v42, v42 row_shr:2 row_mask:0xf bank_mask:0xf
    v_add_f32_dpp v44, v44, v44 row_shr:2 row_mask:0xf bank_mask:0xf
    s_nop 0
    v_add_f32_dpp v42, v42, v42 row_shr:4 row_mask:0xf bank_mask:0xf
    v_add_f32_dpp v44, v44, v44 row_shr:4 row_mask:0xf bank_mask:0xf
    s_nop 0
    v_add_f32_dpp v42, v42, v42 row_shr:8 row_mask:0xf bank_mask:0xf
    v_add_f32_dpp v44, v44, v44 row_shr:8 row_mask:0xf bank_mask:0xf
    v_cvt_pk_bf16_f32 v46, v42, v44
    s_nop 0
    v_readlane_b32 s74, v46, 15
    v_readlane_b32 s75, v46, 31
    s_lshl_b32 s76, s74, 16
    s_and_b32 s77, s74, 0xffff0000
    v_mov_b32 v54, s76
    v_mov_b32 v55, s77
    s_lshl_b32 s76, s75, 16
    s_and_b32 s77, s75, 0xffff0000
    v_add_f32 v46, s76, 1.0
    v_add_f32 v48, s77, 1.0
    v_cvt_pk_bf16_f32 v50, v46, v48
    v_lshlrev_b32 v52, 16, v50
    v_and_b32 v53, 0xffff0000, v50
    v_and_b32 v8, 3, v2
    v_mul_u32_u24 v8, 1568, v8
    v_lshrrev_b32 v9, 2, v2
    v_lshlrev_b32 v9, 4, v9
    v_lshlrev_b32 v5, 3, v3
    v_add3_u32 v8, v8, v9, v5
    v_add_u32 v8, 135680, v8
    v_lshlrev_b32 v9, 4, v2
    v_add_u32 v9, v9, v5
    v_add_u32 v9, 147712, v9
    s_mov_b32 s74, 0x05040100
    s_mov_b32 s75, 0x07060302
    s_cmp_eq_u32 s28, 0
    s_cbranch_scc1 L_xq_19
    s_waitcnt vmcnt(2)
    s_branch L_xq2_20
L_xq_19:
    s_waitcnt vmcnt(4)
L_xq2_20:
    v_lshlrev_b32 v56, 16, v26
    v_and_b32 v57, 0xffff0000, v26
    v_lshlrev_b32 v64, 16, v10
    v_and_b32 v65, 0xffff0000, v10
    v_rcp_f32 v57, v57
    v_lshlrev_b32 v58, 16, v28
    v_and_b32 v59, 0xffff0000, v28
    v_lshlrev_b32 v66, 16, v11
    v_and_b32 v67, 0xffff0000, v11
    v_rcp_f32 v59, v59
    v_lshlrev_b32 v60, 16, v30
    v_and_b32 v61, 0xffff0000, v30
    v_lshlrev_b32 v68, 16, v12
    v_and_b32 v69, 0xffff0000, v12
    v_rcp_f32 v61, v61
    v_lshlrev_b32 v62, 16, v32
    v_and_b32 v63, 0xffff0000, v32
    v_lshlrev_b32 v70, 16, v13
    v_and_b32 v71, 0xffff0000, v13
    v_rcp_f32 v63, v63
    v_pk_add_f32 v[64:65], v[64:65], v[56:57] op_sel_hi:[1,0] neg_lo:[0,1] neg_hi:[0,1]
    v_pk_add_f32 v[66:67], v[66:67], v[58:59] op_sel_hi:[1,0] neg_lo:[0,1] neg_hi:[0,1]
    v_pk_add_f32 v[68:69], v[68:69], v[60:61] op_sel_hi:[1,0] neg_lo:[0,1] neg_hi:[0,1]
    v_pk_add_f32 v[70:71], v[70:71], v[62:63] op_sel_hi:[1,0] neg_lo:[0,1] neg_hi:[0,1]
    v_pk_mul_f32 v[64:65], v[64:65], v[56:57] op_sel:[0,1] op_sel_hi:[1,1]
    v_pk_mul_f32 v[66:67], v[66:67], v[58:59] op_sel:[0,1] op_sel_hi:[1,1]
    v_pk_mul_f32 v[68:69], v[68:69], v[60:61] op_sel:[0,1] op_sel_hi:[1,1]
    v_pk_mul_f32 v[70:71], v[70:71], v[62:63] op_sel:[0,1] op_sel_hi:[1,1]
    v_pk_fma_f32 v[64:65], v[64:65], v[52:53], v[54:55]
    v_pk_fma_f32 v[66:67], v[66:67], v[52:53], v[54:55]
    v_pk_fma_f32 v[68:69], v[68:69], v[52:53], v[54:55]
    v_pk_fma_f32 v[70:71], v[70:71], v[52:53], v[54:55]
    v_cvt_pk_bf16_f32 v72, v64, v66
    v_cvt_pk_bf16_f32 v73, v68, v70
    v_cvt_pk_bf16_f32 v74, v65, v67
    v_cvt_pk_bf16_f32 v75, v69, v71
    v_perm_b32 v76, v11, v10, s74
    v_perm_b32 v77, v13, v12, s74
    v_perm_b32 v78, v11, v10, s75
    v_perm_b32 v79, v13, v12, s75
    ds_write_b64 v8, v[72:73] offset:0
    ds_write_b64 v8, v[74:75] offset:6272
    ds_write_b64 v9, v[76:77] offset:0
    ds_write_b64 v9, v[78:79] offset:4096
    v_lshlrev_b32 v56, 16, v34
    v_and_b32 v57, 0xffff0000, v34
    v_lshlrev_b32 v64, 16, v14
    v_and_b32 v65, 0xffff0000, v14
    v_rcp_f32 v57, v57
    v_lshlrev_b32 v58, 16, v36
    v_and_b32 v59, 0xffff0000, v36
    v_lshlrev_b32 v66, 16, v15
    v_and_b32 v67, 0xffff0000, v15
    v_rcp_f32 v59, v59
    v_lshlrev_b32 v60, 16, v38
    v_and_b32 v61, 0xffff0000, v38
    v_lshlrev_b32 v68, 16, v16
    v_and_b32 v69, 0xffff0000, v16
    v_rcp_f32 v61, v61
    v_lshlrev_b32 v62, 16, v40
    v_and_b32 v63, 0xffff0000, v40
    v_lshlrev_b32 v70, 16, v17
    v_and_b32 v71, 0xffff0000, v17
    v_rcp_f32 v63, v63
    v_pk_add_f32 v[64:65], v[64:65], v[56:57] op_sel_hi:[1,0] neg_lo:[0,1] neg_hi:[0,1]
    v_pk_add_f32 v[66:67], v[66:67], v[58:59] op_sel_hi:[1,0] neg_lo:[0,1] neg_hi:[0,1]
    v_pk_add_f32 v[68:69], v[68:69], v[60:61] op_sel_hi:[1,0] neg_lo:[0,1] neg_hi:[0,1]
    v_pk_add_f32 v[70:71], v[70:71], v[62:63] op_sel_hi:[1,0] neg_lo:[0,1] neg_hi:[0,1]
    v_pk_mul_f32 v[64:65], v[64:65], v[56:57] op_sel:[0,1] op_sel_hi:[1,1]
    v_pk_mul_f32 v[66:67], v[66:67], v[58:59] op_sel:[0,1] op_sel_hi:[1,1]
    v_pk_mul_f32 v[68:69], v[68:69], v[60:61] op_sel:[0,1] op_sel_hi:[1,1]
    v_pk_mul_f32 v[70:71], v[70:71], v[62:63] op_sel:[0,1] op_sel_hi:[1,1]
    v_pk_fma_f32 v[64:65], v[64:65], v[52:53], v[54:55]
    v_pk_fma_f32 v[66:67], v[66:67], v[52:53], v[54:55]
    v_pk_fma_f32 v[68:69], v[68:69], v[52:53], v[54:55]
    v_pk_fma_f32 v[70:71], v[70:71], v[52:53], v[54:55]
    v_cvt_pk_bf16_f32 v72, v64, v66
    v_cvt_pk_bf16_f32 v73, v68, v70
    v_cvt_pk_bf16_f32 v74, v65, v67
    v_cvt_pk_bf16_f32 v75, v69, v71
    v_perm_b32 v76, v15, v14, s74
    v_perm_b32 v77, v17, v16, s74
    v_perm_b32 v78, v15, v14, s75
    v_perm_b32 v79, v17, v16, s75
    ds_write_b64 v8, v[72:73] offset:128
    ds_write_b64 v8, v[74:75] offset:6400
    ds_write_b64 v9, v[76:77] offset:512
    ds_write_b64 v9, v[78:79] offset:4608
    s_waitcnt lgkmcnt(0)
    s_barrier
    s_waitcnt vmcnt(0)
    v_mov_b32 v7, 1
    v_mov_b32 v8, 156424
    s_waitcnt lgkmcnt(0)
    s_mov_b64 exec, 1
    ds_add_rtn_u32 v9, v8, v7
    s_mov_b64 exec, -1
    s_waitcnt lgkmcnt(0)
    v_readfirstlane_b32 s30, v9
    s_cmp_eq_u32 s30, 3
    s_cbranch_scc0 L_nof2w_21
    s_lshl_b32 s30, s2, 4
    s_add_u32 s30, s30, 12288
    v_mov_b32 v2, s4
    v_mov_b32 v3, 0
    s_mov_b64 exec, 1
    buffer_store_dword v2, v3, s[8:11], s30 offen sc1
    s_mov_b64 exec, -1
L_nof2w_21:
    s_setprio 1
    s_and_b32 s28, s7, 3
    s_and_b32 s29, s6, 3
    s_lshl_b32 s29, s29, 2
    s_add_u32 s28, s28, s29
    s_lshr_b32 s29, s7, 2
    s_lshr_b32 s79, s6, 2
    s_lshl_b32 s79, s79, 3
    s_add_u32 s29, s29, s79
    s_mov_b32 s99, 100000
    s_sub_u32 s30, s3, 4
    v_lshrrev_b32 v2, 4, v1
    v_and_b32 v3, 15, v1
    v_lshlrev_b32 v4, 2, v2
    v_xor_b32 v3, v3, v4
    v_lshlrev_b32 v3, 4, v3
    v_lshlrev_b32 v2, 12, v2
    v_add_u32 v120, v2, v3
    v_add_u32 v121, 16384, v120
    s_lshl_b32 s95, s28, 8
    s_add_u32 s95, s95, 9437184
    s_lshl_b32 s32, s30, 15
    s_add_u32 s95, s95, s32
    s_lshl_b32 s96, s30, 11
    s_add_u32 s96, s96, 98304
    s_cmp_lg_u32 s30, 0
    s_cbranch_scc1 L_h3w567_22
    v_lshlrev_b32 v2, 4, v1
    s_mov_b32 s31, 557056
L_f1wr_27:
    buffer_load_dword v10, v2, s[8:11], s31 offen offset:0 sc1
    buffer_load_dword v11, v2, s[8:11], s31 offen offset:1024 sc1
    buffer_load_dword v12, v2, s[8:11], s31 offen offset:2048 sc1
    buffer_load_dword v13, v2, s[8:11], s31 offen offset:3072 sc1
    s_waitcnt vmcnt(0)
    v_xor_b32 v250, s4, v10
    v_xor_b32 v251, s4, v11
    v_xor_b32 v252, s4, v12
    v_or3_b32 v250, v250, v251, v252
    v_xor_b32 v251, s4, v13
    v_or_b32 v250, v250, v251
    v_cmp_ne_u32 vcc, 0, v250
    s_cbranch_vccz L_f1wk_28
    s_sub_u32 s99, s99, 1
    s_cmp_eq_u32 s99, 0
    s_cbranch_scc1 L_f1wk_28
    s_sleep 1
    s_branch L_f1wr_27
L_f1wk_28:
    s_mul_i32 s74, s7, 45056
    s_add_u32 s74, s74, 7340032
    v_lshlrev_b32 v15, 7, v1
    s_mov_b32 s75, 6
    buffer_load_dword v14, v15, s[8:11], s74 offen
    s_add_u32 s74, s74, 8192
    buffer_load_dword v14, v15, s[8:11], s74 offen
    s_add_u32 s74, s74, 8192
    buffer_load_dword v14, v15, s[8:11], s74 offen
    s_add_u32 s74, s74, 8192
    buffer_load_dword v14, v15, s[8:11], s74 offen
    s_add_u32 s74, s74, 8192
    buffer_load_dword v14, v15, s[8:11], s74 offen
    s_add_u32 s74, s74, 8192
    buffer_load_dword v14, v15, s[8:11], s74 offen
    s_add_u32 s74, s74, 8192
    s_mov_b32 s99, 100000
    v_lshlrev_b32 v2, 4, v1
    s_mov_b32 s31, 12288
L_f2wr_29:
    buffer_load_dword v10, v2, s[8:11], s31 offen offset:0 sc1
    buffer_load_dword v11, v2, s[8:11], s31 offen offset:1024 sc1
    buffer_load_dword v12, v2, s[8:11], s31 offen offset:2048 sc1
    buffer_load_dword v13, v2, s[8:11], s31 offen offset:3072 sc1
    s_waitcnt vmcnt(0)
    v_xor_b32 v250, s4, v10
    v_xor_b32 v251, s4, v11
    v_xor_b32 v252, s4, v12
    v_or3_b32 v250, v250, v251, v252
    v_xor_b32 v251, s4, v13
    v_or_b32 v250, v250, v251
    v_cmp_ne_u32 vcc, 0, v250
    s_cbranch_vccz L_f2wk_30
    s_sub_u32 s99, s99, 1
    s_cmp_eq_u32 s99, 0
    s_cbranch_scc1 L_f2wk_30
    s_sleep 1
    s_branch L_f2wr_29
L_f2wk_30:
    v_lshlrev_b32 v5, 5, v1
    s_mov_b32 s34, 524288
    buffer_load_dwordx4 v[20:23], v5, s[8:11], s34 offen
    buffer_load_dwordx4 v[24:27], v5, s[8:11], s34 offen offset:16
    v_mov_b32 v7, 1
    v_mov_b32 v8, 156440
    s_waitcnt lgkmcnt(0)
    s_mov_b64 exec, 1
    ds_add_u32 v8, v7
    s_mov_b64 exec, -1
    s_mov_b32 s32, 0x05040100
    s_mov_b32 s33, 0x07060302
    v_mov_b32 v36, 0x3f803f80
    v_mov_b32 v37, 0x3f803f80
    v_mov_b32 v38, 0x3f803f80
    v_mov_b32 v39, 0x3f803f80
    v_mov_b32 v40, 0
    v_mov_b32 v41, 0
    v_mov_b32 v42, 0
    v_mov_b32 v43, 0
    v_lshlrev_b32 v5, 4, v1
    v_add_u32 v5, 156928, v5
    s_waitcnt vmcnt(0)
    v_perm_b32 v28, v21, v20, s32
    v_perm_b32 v32, v21, v20, s33
    v_perm_b32 v29, v23, v22, s32
    v_perm_b32 v33, v23, v22, s33
    v_perm_b32 v30, v25, v24, s32
    v_perm_b32 v34, v25, v24, s33
    v_perm_b32 v31, v27, v26, s32
    v_perm_b32 v35, v27, v26, s33
    ds_write_b128 v5, v[36:39]
    ds_write_b128 v5, v[28:31] offset:1024
    ds_write_b128 v5, v[32:35] offset:2048
    ds_write_b128 v5, v[40:43] offset:3072
    v_mov_b32 v7, 1
    v_mov_b32 v8, 156460
    s_waitcnt lgkmcnt(0)
    s_mov_b64 exec, 1
    ds_add_u32 v8, v7
    s_mov_b64 exec, -1
    v_mov_b32 v8, 156448
    s_mov_b32 s99, 800000
L_evs_31:
    ds_read_b32 v9, v8
    s_waitcnt lgkmcnt(0)
    v_readfirstlane_b32 s79, v9
    s_cmp_ge_u32 s79, 4
    s_cbranch_scc1 L_evk_32
    s_sub_u32 s99, s99, 1
    s_cmp_eq_u32 s99, 0
    s_cbranch_scc1 L_evk_32
    s_sleep 1
    s_branch L_evs_31
L_evk_32:
L_pfrest_33:
    s_cmp_ge_u32 s75, 5
    s_cbranch_scc1 L_pfdone_34
    buffer_load_dword v14, v15, s[8:11], s74 offen
    s_add_u32 s74, s74, 8192
    s_add_u32 s75, s75, 1
    s_branch L_pfrest_33
L_pfdone_34:
    s_mov_b32 s99, 100000
    v_mov_b32 v8, 156432
    s_mov_b32 s99, 800000
L_evs_35:
    ds_read_b32 v9, v8
    s_waitcnt lgkmcnt(0)
    v_readfirstlane_b32 s79, v9
    s_cmp_ge_u32 s79, 4
    s_cbranch_scc1 L_evk_36
    s_sub_u32 s99, s99, 1
    s_cmp_eq_u32 s99, 0
    s_cbranch_scc1 L_evk_36
    s_sleep 1
    s_branch L_evs_35
L_evk_36:
    s_mov_b32 s99, 100000
    v_lshlrev_b32 v2, 4, v1
    s_mov_b32 s31, 4096
L_f2r_37:
    buffer_load_dword v10, v2, s[8:11], s31 offen offset:0 sc1
    buffer_load_dword v11, v2, s[8:11], s31 offen offset:1024 sc1
    buffer_load_dword v12, v2, s[8:11], s31 offen offset:2048 sc1
    buffer_load_dword v13, v2, s[8:11], s31 offen offset:3072 sc1
    s_waitcnt vmcnt(0)
    v_xor_b32 v250, s4, v10
    v_xor_b32 v251, s4, v11
    v_xor_b32 v252, s4, v12
    v_or3_b32 v250, v250, v251, v252
    v_xor_b32 v251, s4, v13
    v_or_b32 v250, v250, v251
    v_cmp_ne_u32 vcc, 0, v250
    s_cbranch_vccz L_f2k_38
    s_sub_u32 s99, s99, 1
    s_cmp_eq_u32 s99, 0
    s_cbranch_scc1 L_f2k_38
    s_sleep 1
    s_branch L_f2r_37
L_f2k_38:
    v_mov_b32 v7, 1
    v_mov_b32 v8, 156420
    s_mov_b64 exec, 1
    ds_write_b32 v8, v7
    s_mov_b64 exec, -1
    s_cmp_eq_u32 s29, 15
    s_cbranch_scc1 L_h3idle_24
    s_branch L_h3go_26
L_h3w567_22:
    s_cmp_eq_u32 s29, 15
    s_cbranch_scc1 L_h3idle2_25
    s_mov_b32 s16, s58
    s_and_b32 s17, s59, 0xffff
    s_mov_b32 s18, 2752
    s_mov_b32 s19, 0x20000
    s_mul_i32 s74, s29, 192
    s_sub_u32 s75, s30, 1
    s_lshl_b32 s75, s75, 6
    s_add_u32 s74, s74, s75
    v_lshrrev_b32 v13, 5, v1
    v_lshlrev_b32 v13, 3, v13
    buffer_load_dwordx2 v[64:65], v13, s[16:19], s74 offen offset:0
    buffer_load_dwordx2 v[66:67], v13, s[16:19], s74 offen offset:16
    buffer_load_dwordx2 v[68:69], v13, s[16:19], s74 offen offset:32
    buffer_load_dwordx2 v[70:71], v13, s[16:19], s74 offen offset:48
    v_mov_b32 v8, 156440
    s_mov_b32 s99, 800000
L_evs_39:
    ds_read_b32 v9, v8
    s_waitcnt lgkmcnt(0)
    v_readfirstlane_b32 s79, v9
    s_cmp_ge_u32 s79, 1
    s_cbranch_scc1 L_evk_40
    s_sub_u32 s99, s99, 1
    s_cmp_eq_u32 s99, 0
    s_cbranch_scc1 L_evk_40
    s_sleep 1
    s_branch L_evs_39
L_evk_40:
    v_lshlrev_b32 v10, 4, v1
    s_sub_u32 s74, s30, 1
    s_lshl_b32 s74, s74, 10
    s_add_u32 s33, s74, 36864
    s_mul_i32 s31, s29, 98304
    s_add_u32 s31, s31, 5242880
    s_add_u32 s31, s31, s33
    s_mov_b32 m0, s33
    s_nop 0
    buffer_load_dwordx4 v10, s[8:11], s31 offen lds
    s_add_u32 s31, s31, 3072
    s_add_u32 s33, s33, 3072
    s_mov_b32 m0, s33
    s_nop 0
    buffer_load_dwordx4 v10, s[8:11], s31 offen lds
    s_add_u32 s31, s31, 3072
    s_add_u32 s33, s33, 3072
    s_mov_b32 m0, s33
    s_nop 0
    buffer_load_dwordx4 v10, s[8:11], s31 offen lds
    s_add_u32 s31, s31, 3072
    s_add_u32 s33, s33, 3072
    s_mov_b32 m0, s33
    s_nop 0
    buffer_load_dwordx4 v10, s[8:11], s31 offen lds
    s_add_u32 s31, s31, 3072
    s_add_u32 s33, s33, 3072
    s_mov_b32 m0, s33
    s_nop 0
    buffer_load_dwordx4 v10, s[8:11], s31 offen lds
    s_add_u32 s31, s31, 3072
    s_add_u32 s33, s33, 3072
    s_mov_b32 m0, s33
    s_nop 0
    buffer_load_dwordx4 v10, s[8:11], s31 offen lds
    s_add_u32 s31, s31, 3072
    s_add_u32 s33, s33, 3072
    s_mov_b32 m0, s33
    s_nop 0
    buffer_load_dwordx4 v10, s[8:11], s31 offen lds
    s_add_u32 s31, s31, 3072
    s_add_u32 s33, s33, 3072
    s_mov_b32 m0, s33
    s_nop 0
    buffer_load_dwordx4 v10, s[8:11], s31 offen lds
    s_add_u32 s31, s31, 3072
    s_add_u32 s33, s33, 3072
    s_mov_b32 m0, s33
    s_nop 0
    buffer_load_dwordx4 v10, s[8:11], s31 offen lds
    s_add_u32 s31, s31, 3072
    s_add_u32 s33, s33, 3072
    s_mov_b32 m0, s33
    s_nop 0
    buffer_load_dwordx4 v10, s[8:11], s31 offen lds
    s_add_u32 s31, s31, 3072
    s_add_u32 s33, s33, 3072
    s_mov_b32 m0, s33
    s_nop 0
    buffer_load_dwordx4 v10, s[8:11], s31 offen lds
    s_add_u32 s31, s31, 3072
    s_add_u32 s33, s33, 3072
    s_mov_b32 m0, s33
    s_nop 0
    buffer_load_dwordx4 v10, s[8:11], s31 offen lds
    s_add_u32 s31, s31, 3072
    s_add_u32 s33, s33, 3072
    s_mov_b32 m0, s33
    s_nop 0
    buffer_load_dwordx4 v10, s[8:11], s31 offen lds
    s_add_u32 s31, s31, 3072
    s_add_u32 s33, s33, 3072
    s_mov_b32 m0, s33
    s_nop 0
    buffer_load_dwordx4 v10, s[8:11], s31 offen lds
    s_add_u32 s31, s31, 3072
    s_add_u32 s33, s33, 3072
    s_mov_b32 m0, s33
    s_nop 0
    buffer_load_dwordx4 v10, s[8:11], s31 offen lds
    s_add_u32 s31, s31, 3072
    s_add_u32 s33, s33, 3072
    s_mov_b32 m0, s33
    s_nop 0
    buffer_load_dwordx4 v10, s[8:11], s31 offen lds
    s_add_u32 s31, s31, 3072
    s_add_u32 s33, s33, 3072
    s_mov_b32 m0, s33
    s_nop 0
    buffer_load_dwordx4 v10, s[8:11], s31 offen lds
    s_add_u32 s31, s31, 3072
    s_add_u32 s33, s33, 3072
    s_mov_b32 m0, s33
    s_nop 0
    buffer_load_dwordx4 v10, s[8:11], s31 offen lds
    s_add_u32 s31, s31, 3072
    s_add_u32 s33, s33, 3072
    s_mov_b32 m0, s33
    s_nop 0
    buffer_load_dwordx4 v10, s[8:11], s31 offen lds
    s_add_u32 s31, s31, 3072
    s_add_u32 s33, s33, 3072
    s_mov_b32 m0, s33
    s_nop 0
    buffer_load_dwordx4 v10, s[8:11], s31 offen lds
    v_mov_b32 v8, 156468
    s_mov_b32 s99, 800000
L_evs_41:
    ds_read_b32 v9, v8
    s_waitcnt lgkmcnt(0)
    v_readfirstlane_b32 s79, v9
    s_cmp_ge_u32 s79, 4
    s_cbranch_scc1 L_evk_42
    s_sub_u32 s99, s99, 1
    s_cmp_eq_u32 s99, 0
    s_cbranch_scc1 L_evk_42
    s_sleep 1
    s_branch L_evs_41
L_evk_42:
    v_lshlrev_b32 v10, 4, v1
    s_sub_u32 s74, s30, 1
    s_lshl_b32 s74, s74, 10
    s_add_u32 s33, s74, 0
    s_mul_i32 s31, s29, 98304
    s_add_u32 s31, s31, 5242880
    s_add_u32 s31, s31, s33
    s_mov_b32 m0, s33
    s_nop 0
    buffer_load_dwordx4 v10, s[8:11], s31 offen lds
    s_add_u32 s31, s31, 3072
    s_add_u32 s33, s33, 3072
    s_mov_b32 m0, s33
    s_nop 0
    buffer_load_dwordx4 v10, s[8:11], s31 offen lds
    s_add_u32 s31, s31, 3072
    s_add_u32 s33, s33, 3072
    s_mov_b32 m0, s33
    s_nop 0
    buffer_load_dwordx4 v10, s[8:11], s31 offen lds
    s_add_u32 s31, s31, 3072
    s_add_u32 s33, s33, 3072
    s_mov_b32 m0, s33
    s_nop 0
    buffer_load_dwordx4 v10, s[8:11], s31 offen lds
    s_add_u32 s31, s31, 3072
    s_add_u32 s33, s33, 3072
    s_mov_b32 m0, s33
    s_nop 0
    buffer_load_dwordx4 v10, s[8:11], s31 offen lds
    s_add_u32 s31, s31, 3072
    s_add_u32 s33, s33, 3072
    s_mov_b32 m0, s33
    s_nop 0
    buffer_load_dwordx4 v10, s[8:11], s31 offen lds
    s_add_u32 s31, s31, 3072
    s_add_u32 s33, s33, 3072
    s_mov_b32 m0, s33
    s_nop 0
    buffer_load_dwordx4 v10, s[8:11], s31 offen lds
    s_add_u32 s31, s31, 3072
    s_add_u32 s33, s33, 3072
    s_mov_b32 m0, s33
    s_nop 0
    buffer_load_dwordx4 v10, s[8:11], s31 offen lds
    s_add_u32 s31, s31, 3072
    s_add_u32 s33, s33, 3072
    s_mov_b32 m0, s33
    s_nop 0
    buffer_load_dwordx4 v10, s[8:11], s31 offen lds
    s_add_u32 s31, s31, 3072
    s_add_u32 s33, s33, 3072
    s_mov_b32 m0, s33
    s_nop 0
    buffer_load_dwordx4 v10, s[8:11], s31 offen lds
    s_add_u32 s31, s31, 3072
    s_add_u32 s33, s33, 3072
    s_mov_b32 m0, s33
    s_nop 0
    buffer_load_dwordx4 v10, s[8:11], s31 offen lds
    s_add_u32 s31, s31, 3072
    s_add_u32 s33, s33, 3072
    s_mov_b32 m0, s33
    s_nop 0
    buffer_load_dwordx4 v10, s[8:11], s31 offen lds
L_h3idle2_25:
    s_waitcnt vmcnt(0)
    v_mov_b32 v7, 1
    v_mov_b32 v8, 156456
    s_waitcnt lgkmcnt(0)
    s_mov_b64 exec, 1
    ds_add_u32 v8, v7
    s_mov_b64 exec, -1
    s_cmp_eq_u32 s29, 15
    s_cbranch_scc1 L_nost_43
    s_sub_u32 s74, s30, 1
    v_lshrrev_b32 v2, 5, v1
    v_bfe_u32 v3, v1, 2, 2
    v_bfe_u32 v4, v1, 4, 1
    v_and_b32 v5, 3, v1
    v_lshlrev_b32 v6, 3, v2
    v_add_u32 v6, v6, v3
    v_lshlrev_b32 v7, 5, v4
    v_lshlrev_b32 v8, 3, v5
    v_add_u32 v7, v7, v8
    v_mul_u32_u24 v10, 192, v6
    v_add_u32 v10, v10, v7
    s_lshl_b32 s75, s74, 6
    v_add_u32 v72, s75, v10
    v_add_u32 v73, 49152, v72
    v_and_b32 v13, 31, v1
    v_min_u32 v14, 3, v13
    v_lshlrev_b32 v14, 10, v14
    v_lshlrev_b32 v15, 4, v2
    v_add_u32 v14, v14, v15
    v_add_u32 v14, 156928, v14
    v_cmp_eq_u32 vcc, 1, v13
    s_waitcnt vmcnt(0)
    v_lshlrev_b32 v74, 16, v64
    v_cndmask_b32 v16, 0, v74, vcc
    v_and_b32 v74, 0xffff0000, v64
    v_cndmask_b32 v17, 0, v74, vcc
    v_lshlrev_b32 v74, 16, v65
    v_cndmask_b32 v18, 0, v74, vcc
    v_and_b32 v74, 0xffff0000, v65
    v_cndmask_b32 v19, 0, v74, vcc
    v_lshlrev_b32 v74, 16, v66
    v_cndmask_b32 v20, 0, v74, vcc
    v_and_b32 v74, 0xffff0000, v66
    v_cndmask_b32 v21, 0, v74, vcc
    v_lshlrev_b32 v74, 16, v67
    v_cndmask_b32 v22, 0, v74, vcc
    v_and_b32 v74, 0xffff0000, v67
    v_cndmask_b32 v23, 0, v74, vcc
    v_lshlrev_b32 v74, 16, v68
    v_cndmask_b32 v24, 0, v74, vcc
    v_and_b32 v74, 0xffff0000, v68
    v_cndmask_b32 v25, 0, v74, vcc
    v_lshlrev_b32 v74, 16, v69
    v_cndmask_b32 v26, 0, v74, vcc
    v_and_b32 v74, 0xffff0000, v69
    v_cndmask_b32 v27, 0, v74, vcc
    v_lshlrev_b32 v74, 16, v70
    v_cndmask_b32 v28, 0, v74, vcc
    v_and_b32 v74, 0xffff0000, v70
    v_cndmask_b32 v29, 0, v74, vcc
    v_lshlrev_b32 v74, 16, v71
    v_cndmask_b32 v30, 0, v74, vcc
    v_and_b32 v74, 0xffff0000, v71
    v_cndmask_b32 v31, 0, v74, vcc
    v_mov_b32 v76, 156456
    s_mov_b32 s99, 800000
L_evs_44:
    ds_read_b32 v77, v76
    s_waitcnt lgkmcnt(0)
    v_readfirstlane_b32 s79, v77
    s_cmp_ge_u32 s79, 3
    s_cbranch_scc1 L_evk_45
    s_sub_u32 s99, s99, 1
    s_cmp_eq_u32 s99, 0
    s_cbranch_scc1 L_evk_45
    s_sleep 1
    s_branch L_evs_44
L_evk_45:
    v_mov_b32 v76, 156460
    s_mov_b32 s99, 800000
L_evs_46:
    ds_read_b32 v77, v76
    s_waitcnt lgkmcnt(0)
    v_readfirstlane_b32 s79, v77
    s_cmp_ge_u32 s79, 1
    s_cbranch_scc1 L_evk_47
    s_sub_u32 s99, s99, 1
    s_cmp_eq_u32 s99, 0
    s_cbranch_scc1 L_evk_47
    s_sleep 1
    s_branch L_evs_46
L_evk_47:
    ds_read_b64_tr_b16 v[80:81], v72 offset:0
    ds_read_b64_tr_b16 v[82:83], v72 offset:768
    ds_read_b128 v[84:87], v14 offset:0
    ds_read_b64_tr_b16 v[88:89], v72 offset:3072
    ds_read_b64_tr_b16 v[90:91], v72 offset:3840
    ds_read_b128 v[92:95], v14 offset:32
    ds_read_b64_tr_b16 v[96:97], v72 offset:6144
    ds_read_b64_tr_b16 v[98:99], v72 offset:6912
    ds_read_b128 v[100:103], v14 offset:64
    ds_read_b64_tr_b16 v[104:105], v72 offset:9216
    ds_read_b64_tr_b16 v[106:107], v72 offset:9984
    ds_read_b128 v[108:111], v14 offset:96
    s_waitcnt lgkmcnt(9)
    v_mfma_f32_32x32x16_bf16 v[16:31], v[80:83], v[84:87], v[16:31]
    ds_read_b64_tr_b16 v[80:81], v72 offset:12288
    ds_read_b64_tr_b16 v[82:83], v72 offset:13056
    ds_read_b128 v[84:87], v14 offset:128
    s_waitcnt lgkmcnt(9)
    v_mfma_f32_32x32x16_bf16 v[16:31], v[88:91], v[92:95], v[16:31]
    ds_read_b64_tr_b16 v[88:89], v72 offset:15360
    ds_read_b64_tr_b16 v[90:91], v72 offset:16128
    ds_read_b128 v[92:95], v14 offset:160
    s_waitcnt lgkmcnt(9)
    v_mfma_f32_32x32x16_bf16 v[16:31], v[96:99], v[100:103], v[16:31]
    ds_read_b64_tr_b16 v[96:97], v72 offset:18432
    ds_read_b64_tr_b16 v[98:99], v72 offset:19200
    ds_read_b128 v[100:103], v14 offset:192
    s_waitcnt lgkmcnt(9)
    v_mfma_f32_32x32x16_bf16 v[16:31], v[104:107], v[108:111], v[16:31]
    ds_read_b64_tr_b16 v[104:105], v72 offset:21504
    ds_read_b64_tr_b16 v[106:107], v72 offset:22272
    ds_read_b128 v[108:111], v14 offset:224
    s_waitcnt lgkmcnt(9)
    v_mfma_f32_32x32x16_bf16 v[16:31], v[80:83], v[84:87], v[16:31]
    ds_read_b64_tr_b16 v[80:81], v72 offset:24576
    ds_read_b64_tr_b16 v[82:83], v72 offset:25344
    ds_read_b128 v[84:87], v14 offset:256
    s_waitcnt lgkmcnt(9)
    v_mfma_f32_32x32x16_bf16 v[16:31], v[88:91], v[92:95], v[16:31]
    ds_read_b64_tr_b16 v[88:89], v72 offset:27648
    ds_read_b64_tr_b16 v[90:91], v72 offset:28416
    ds_read_b128 v[92:95], v14 offset:288
    s_waitcnt lgkmcnt(9)
    v_mfma_f32_32x32x16_bf16 v[16:31], v[96:99], v[100:103], v[16:31]
    ds_read_b64_tr_b16 v[96:97], v72 offset:30720
    ds_read_b64_tr_b16 v[98:99], v72 offset:31488
    ds_read_b128 v[100:103], v14 offset:320
    s_waitcnt lgkmcnt(9)
    v_mfma_f32_32x32x16_bf16 v[16:31], v[104:107], v[108:111], v[16:31]
    ds_read_b64_tr_b16 v[104:105], v72 offset:33792
    ds_read_b64_tr_b16 v[106:107], v72 offset:34560
    ds_read_b128 v[108:111], v14 offset:352
    s_waitcnt lgkmcnt(9)
    v_mfma_f32_32x32x16_bf16 v[16:31], v[80:83], v[84:87], v[16:31]
    ds_read_b64_tr_b16 v[80:81], v72 offset:36864
    ds_read_b64_tr_b16 v[82:83], v72 offset:37632
    ds_read_b128 v[84:87], v14 offset:384
    s_waitcnt lgkmcnt(9)
    v_mfma_f32_32x32x16_bf16 v[16:31], v[88:91], v[92:95], v[16:31]
    ds_read_b64_tr_b16 v[88:89], v72 offset:39936
    ds_read_b64_tr_b16 v[90:91], v72 offset:40704
    ds_read_b128 v[92:95], v14 offset:416
    s_waitcnt lgkmcnt(9)
    v_mfma_f32_32x32x16_bf16 v[16:31], v[96:99], v[100:103], v[16:31]
    ds_read_b64_tr_b16 v[96:97], v72 offset:43008
    ds_read_b64_tr_b16 v[98:99], v72 offset:43776
    ds_read_b128 v[100:103], v14 offset:448
    s_waitcnt lgkmcnt(9)
    v_mfma_f32_32x32x16_bf16 v[16:31], v[104:107], v[108:111], v[16:31]
    ds_read_b64_tr_b16 v[104:105], v72 offset:46080
    ds_read_b64_tr_b16 v[106:107], v72 offset:46848
    ds_read_b128 v[108:111], v14 offset:480
    s_waitcnt lgkmcnt(9)
    v_mfma_f32_32x32x16_bf16 v[16:31], v[80:83], v[84:87], v[16:31]
    ds_read_b64_tr_b16 v[80:81], v73 offset:0
    ds_read_b64_tr_b16 v[82:83], v73 offset:768
    ds_read_b128 v[84:87], v14 offset:512
    s_waitcnt lgkmcnt(9)
    v_mfma_f32_32x32x16_bf16 v[16:31], v[88:91], v[92:95], v[16:31]
    ds_read_b64_tr_b16 v[88:89], v73 offset:3072
    ds_read_b64_tr_b16 v[90:91], v73 offset:3840
    ds_read_b128 v[92:95], v14 offset:544
    s_waitcnt lgkmcnt(9)
    v_mfma_f32_32x32x16_bf16 v[16:31], v[96:99], v[100:103], v[16:31]
    ds_read_b64_tr_b16 v[96:97], v73 offset:6144
    ds_read_b64_tr_b16 v[98:99], v73 offset:6912
    ds_read_b128 v[100:103], v14 offset:576
    s_waitcnt lgkmcnt(9)
    v_mfma_f32_32x32x16_bf16 v[16:31], v[104:107], v[108:111], v[16:31]
    ds_read_b64_tr_b16 v[104:105], v73 offset:9216
    ds_read_b64_tr_b16 v[106:107], v73 offset:9984
    ds_read_b128 v[108:111], v14 offset:608
    s_waitcnt lgkmcnt(9)
    v_mfma_f32_32x32x16_bf16 v[16:31], v[80:83], v[84:87], v[16:31]
    ds_read_b64_tr_b16 v[80:81], v73 offset:12288
    ds_read_b64_tr_b16 v[82:83], v73 offset:13056
    ds_read_b128 v[84:87], v14 offset:640
    s_waitcnt lgkmcnt(9)
    v_mfma_f32_32x32x16_bf16 v[16:31], v[88:91], v[92:95], v[16:31]
    ds_read_b64_tr_b16 v[88:89], v73 offset:15360
    ds_read_b64_tr_b16 v[90:91], v73 offset:16128
    ds_read_b128 v[92:95], v14 offset:672
    s_waitcnt lgkmcnt(9)
    v_mfma_f32_32x32x16_bf16 v[16:31], v[96:99], v[100:103], v[16:31]
    ds_read_b64_tr_b16 v[96:97], v73 offset:18432
    ds_read_b64_tr_b16 v[98:99], v73 offset:19200
    ds_read_b128 v[100:103], v14 offset:704
    s_waitcnt lgkmcnt(9)
    v_mfma_f32_32x32x16_bf16 v[16:31], v[104:107], v[108:111], v[16:31]
    ds_read_b64_tr_b16 v[104:105], v73 offset:21504
    ds_read_b64_tr_b16 v[106:107], v73 offset:22272
    ds_read_b128 v[108:111], v14 offset:736
    s_waitcnt lgkmcnt(9)
    v_mfma_f32_32x32x16_bf16 v[16:31], v[80:83], v[84:87], v[16:31]
    ds_read_b64_tr_b16 v[80:81], v73 offset:24576
    ds_read_b64_tr_b16 v[82:83], v73 offset:25344
    ds_read_b128 v[84:87], v14 offset:768
    s_waitcnt lgkmcnt(9)
    v_mfma_f32_32x32x16_bf16 v[16:31], v[88:91], v[92:95], v[16:31]
    ds_read_b64_tr_b16 v[88:89], v73 offset:27648
    ds_read_b64_tr_b16 v[90:91], v73 offset:28416
    ds_read_b128 v[92:95], v14 offset:800
    s_waitcnt lgkmcnt(9)
    v_mfma_f32_32x32x16_bf16 v[16:31], v[96:99], v[100:103], v[16:31]
    ds_read_b64_tr_b16 v[96:97], v73 offset:30720
    ds_read_b64_tr_b16 v[98:99], v73 offset:31488
    ds_read_b128 v[100:103], v14 offset:832
    s_waitcnt lgkmcnt(9)
    v_mfma_f32_32x32x16_bf16 v[16:31], v[104:107], v[108:111], v[16:31]
    ds_read_b64_tr_b16 v[104:105], v73 offset:33792
    ds_read_b64_tr_b16 v[106:107], v73 offset:34560
    ds_read_b128 v[108:111], v14 offset:864
    s_waitcnt lgkmcnt(9)
    v_mfma_f32_32x32x16_bf16 v[16:31], v[80:83], v[84:87], v[16:31]
    ds_read_b64_tr_b16 v[80:81], v73 offset:36864
    ds_read_b64_tr_b16 v[82:83], v73 offset:37632
    ds_read_b128 v[84:87], v14 offset:896
    s_waitcnt lgkmcnt(9)
    v_mfma_f32_32x32x16_bf16 v[16:31], v[88:91], v[92:95], v[16:31]
    ds_read_b64_tr_b16 v[88:89], v73 offset:39936
    ds_read_b64_tr_b16 v[90:91], v73 offset:40704
    ds_read_b128 v[92:95], v14 offset:928
    s_waitcnt lgkmcnt(9)
    v_mfma_f32_32x32x16_bf16 v[16:31], v[96:99], v[100:103], v[16:31]
    ds_read_b64_tr_b16 v[96:97], v73 offset:43008
    ds_read_b64_tr_b16 v[98:99], v73 offset:43776
    ds_read_b128 v[100:103], v14 offset:960
    s_waitcnt lgkmcnt(9)
    v_mfma_f32_32x32x16_bf16 v[16:31], v[104:107], v[108:111], v[16:31]
    ds_read_b64_tr_b16 v[104:105], v73 offset:46080
    ds_read_b64_tr_b16 v[106:107], v73 offset:46848
    ds_read_b128 v[108:111], v14 offset:992
    s_waitcnt lgkmcnt(9)
    v_mfma_f32_32x32x16_bf16 v[16:31], v[80:83], v[84:87], v[16:31]
    s_waitcnt lgkmcnt(6)
    v_mfma_f32_32x32x16_bf16 v[16:31], v[88:91], v[92:95], v[16:31]
    s_waitcnt lgkmcnt(3)
    v_mfma_f32_32x32x16_bf16 v[16:31], v[96:99], v[100:103], v[16:31]
    s_waitcnt lgkmcnt(0)
    v_mfma_f32_32x32x16_bf16 v[16:31], v[104:107], v[108:111], v[16:31]
    s_nop 11
    v_mov_b32_dpp v32, v16 row_shl:1 row_mask:0xf bank_mask:0xf bound_ctrl:1
    v_mov_b32_dpp v33, v17 row_shl:1 row_mask:0xf bank_mask:0xf bound_ctrl:1
    v_mov_b32_dpp v34, v18 row_shl:1 row_mask:0xf bank_mask:0xf bound_ctrl:1
    v_mov_b32_dpp v35, v19 row_shl:1 row_mask:0xf bank_mask:0xf bound_ctrl:1
    v_mov_b32_dpp v36, v20 row_shl:1 row_mask:0xf bank_mask:0xf bound_ctrl:1
    v_mov_b32_dpp v37, v21 row_shl:1 row_mask:0xf bank_mask:0xf bound_ctrl:1
    v_mov_b32_dpp v38, v22 row_shl:1 row_mask:0xf bank_mask:0xf bound_ctrl:1
    v_mov_b32_dpp v39, v23 row_shl:1 row_mask:0xf bank_mask:0xf bound_ctrl:1
    v_mov_b32_dpp v40, v24 row_shl:1 row_mask:0xf bank_mask:0xf bound_ctrl:1
    v_mov_b32_dpp v41, v25 row_shl:1 row_mask:0xf bank_mask:0xf bound_ctrl:1
    v_mov_b32_dpp v42, v26 row_shl:1 row_mask:0xf bank_mask:0xf bound_ctrl:1
    v_mov_b32_dpp v43, v27 row_shl:1 row_mask:0xf bank_mask:0xf bound_ctrl:1
    v_mov_b32_dpp v44, v28 row_shl:1 row_mask:0xf bank_mask:0xf bound_ctrl:1
    v_mov_b32_dpp v45, v29 row_shl:1 row_mask:0xf bank_mask:0xf bound_ctrl:1
    v_mov_b32_dpp v46, v30 row_shl:1 row_mask:0xf bank_mask:0xf bound_ctrl:1
    v_mov_b32_dpp v47, v31 row_shl:1 row_mask:0xf bank_mask:0xf bound_ctrl:1
    v_add_f32 v32, v32, v16
    v_add_f32 v33, v33, v17
    v_add_f32 v34, v34, v18
    v_add_f32 v35, v35, v19
    v_add_f32 v36, v36, v20
    v_add_f32 v37, v37, v21
    v_add_f32 v38, v38, v22
    v_add_f32 v39, v39, v23
    v_add_f32 v40, v40, v24
    v_add_f32 v41, v41, v25
    v_add_f32 v42, v42, v26
    v_add_f32 v43, v43, v27
    v_add_f32 v44, v44, v28
    v_add_f32 v45, v45, v29
    v_add_f32 v46, v46, v30
    v_add_f32 v47, v47, v31
    v_lshlrev_b32 v75, 4, v2
    s_lshl_b32 s75, s74, 7
    v_add_u32 v75, s75, v75
    v_add_u32 v75, 161024, v75
    s_mov_b32 exec_lo, 1
    s_mov_b32 exec_hi, 1
    ds_write_b128 v75, v[16:19] offset:0
    ds_write_b128 v75, v[20:23] offset:32
    ds_write_b128 v75, v[24:27] offset:64
    ds_write_b128 v75, v[28:31] offset:96
    s_mov_b32 exec_lo, 2
    s_mov_b32 exec_hi, 2
    ds_write_b128 v75, v[32:35] offset:384
    ds_write_b128 v75, v[36:39] offset:416
    ds_write_b128 v75, v[40:43] offset:448
    ds_write_b128 v75, v[44:47] offset:480
    s_mov_b64 exec, -1
    s_waitcnt lgkmcnt(0)
L_nost_43:
L_h3join_23:
    s_cmp_eq_u32 s29, 15
    s_cbranch_scc1 L_h3idle_24
    v_mov_b32 v8, 156432
    s_mov_b32 s99, 800000
L_evs_48:
    ds_read_b32 v9, v8
    s_waitcnt lgkmcnt(0)
    v_readfirstlane_b32 s79, v9
    s_cmp_ge_u32 s79, 4
    s_cbranch_scc1 L_evk_49
    s_sub_u32 s99, s99, 1
    s_cmp_eq_u32 s99, 0
    s_cbranch_scc1 L_evk_49
    s_sleep 1
    s_branch L_evs_48
L_evk_49:
    v_mov_b32 v8, 156420
    s_mov_b32 s99, 800000
L_evs_50:
    ds_read_b32 v9, v8
    s_waitcnt lgkmcnt(0)
    v_readfirstlane_b32 s79, v9
    s_cmp_ge_u32 s79, 1
    s_cbranch_scc1 L_evk_51
    s_sub_u32 s99, s99, 1
    s_cmp_eq_u32 s99, 0
    s_cbranch_scc1 L_evk_51
    s_nop 0
    s_branch L_evs_50
L_evk_51:
L_h3go_26:
    s_add_u32 m0, s96, 0
    s_add_u32 s34, s29, 0
    s_and_b32 s34, s34, 15
    s_lshl_b32 s34, s34, 17
    s_add_u32 s34, s34, s95
    buffer_load_dwordx4 v120, s[8:11], s34 offen lds
    s_add_u32 m0, s96, 1024
    s_nop 0
    buffer_load_dwordx4 v121, s[8:11], s34 offen lds
    s_add_u32 m0, s96, 8192
    s_add_u32 s34, s29, 1
    s_and_b32 s34, s34, 15
    s_lshl_b32 s34, s34, 17
    s_add_u32 s34, s34, s95
    buffer_load_dwordx4 v120, s[8:11], s34 offen lds
    s_add_u32 m0, s96, 9216
    s_nop 0
    buffer_load_dwordx4 v121, s[8:11], s34 offen lds
    s_add_u32 m0, s96, 16384
    s_add_u32 s34, s29, 2
    s_and_b32 s34, s34, 15
    s_lshl_b32 s34, s34, 17
    s_add_u32 s34, s34, s95
    buffer_load_dwordx4 v120, s[8:11], s34 offen lds
    s_add_u32 m0, s96, 17408
    s_nop 0
    buffer_load_dwordx4 v121, s[8:11], s34 offen lds
    s_add_u32 m0, s96, 24576
    s_add_u32 s34, s29, 3
    s_and_b32 s34, s34, 15
    s_lshl_b32 s34, s34, 17
    s_add_u32 s34, s34, s95
    buffer_load_dwordx4 v120, s[8:11], s34 offen lds
    s_add_u32 m0, s96, 25600
    s_nop 0
    buffer_load_dwordx4 v121, s[8:11], s34 offen lds
    s_cmp_lg_u32 s30, 0
    s_cbranch_scc1 L_nox2pf_52
    v_lshrrev_b32 v2, 1, v1
    s_lshr_b32 s74, s7, 2
    s_lshl_b32 s74, s74, 6
    v_add_u32 v2, s74, v2
    v_lshlrev_b32 v2, 12, v2
    v_and_b32 v3, 1, v1
    v_lshlrev_b32 v3, 7, v3
    v_add_u32 v2, v2, v3
    s_lshl_b32 s74, s28, 8
    s_add_u32 s74, s74, 9437184
    buffer_load_dword v14, v2, s[8:11], s74 offen
    s_add_u32 s74, s74, 131072
    buffer_load_dword v14, v2, s[8:11], s74 offen
L_nox2pf_52:
    s_lshl_b32 s74, s28, 15
    s_lshl_b32 s75, s30, 9
    s_add_u32 s74, s74, s75
    s_add_u32 s94, s74, 589824
    v_and_b32 v148, 31, v1
    v_lshlrev_b32 v148, 4, v148
    v_lshrrev_b32 v149, 5, v1
    v_lshlrev_b32 v149, 14, v149
    v_add_u32 v148, v148, v149
    s_mov_b32 s97, s94
    s_cmp_eq_u32 s30, 0
    s_cbranch_scc1 L_s4_53
    s_waitcnt vmcnt(6)
    s_branch L_s4b_54
L_s4_53:
    s_waitcnt vmcnt(8)
L_s4b_54:
    s_barrier
    s_add_u32 m0, s96, 32768
    s_add_u32 s34, s29, 4
    s_and_b32 s34, s34, 15
    s_lshl_b32 s34, s34, 17
    s_add_u32 s34, s34, s95
    buffer_load_dwordx4 v120, s[8:11], s34 offen lds
    s_add_u32 m0, s96, 33792
    s_nop 0
    buffer_load_dwordx4 v121, s[8:11], s34 offen lds
    s_cmp_eq_u32 s30, 0
    s_cbranch_scc1 L_s4_55
    s_waitcnt vmcnt(6)
    s_branch L_s4b_56
L_s4_55:
    s_waitcnt vmcnt(8)
L_s4b_56:
    s_barrier
    s_add_u32 m0, s96, 40960
    s_add_u32 s34, s29, 5
    s_and_b32 s34, s34, 15
    s_lshl_b32 s34, s34, 17
    s_add_u32 s34, s34, s95
    buffer_load_dwordx4 v120, s[8:11], s34 offen lds
    s_add_u32 m0, s96, 41984
    s_nop 0
    buffer_load_dwordx4 v121, s[8:11], s34 offen lds
    s_cmp_eq_u32 s30, 0
    s_cbranch_scc1 L_s4_57
    s_waitcnt vmcnt(6)
    s_branch L_s4b_58
L_s4_57:
    s_waitcnt vmcnt(8)
L_s4b_58:
    s_barrier
    s_add_u32 m0, s96, 0
    s_add_u32 s34, s29, 6
    s_and_b32 s34, s34, 15
    s_lshl_b32 s34, s34, 17
    s_add_u32 s34, s34, s95
    buffer_load_dwordx4 v120, s[8:11], s34 offen lds
    s_add_u32 m0, s96, 1024
    s_nop 0
    buffer_load_dwordx4 v121, s[8:11], s34 offen lds
    s_cmp_eq_u32 s30, 0
    s_cbranch_scc1 L_s4_59
    s_waitcnt vmcnt(6)
    s_branch L_s4b_60
L_s4_59:
    s_waitcnt vmcnt(8)
L_s4b_60:
    s_barrier
    s_add_u32 m0, s96, 8192
    s_add_u32 s34, s29, 7
    s_and_b32 s34, s34, 15
    s_lshl_b32 s34, s34, 17
    s_add_u32 s34, s34, s95
    buffer_load_dwordx4 v120, s[8:11], s34 offen lds
    s_add_u32 m0, s96, 9216
    s_nop 0
    buffer_load_dwordx4 v121, s[8:11], s34 offen lds
    s_waitcnt vmcnt(6)
    s_barrier
    s_add_u32 m0, s96, 16384
    s_add_u32 s34, s29, 8
    s_and_b32 s34, s34, 15
    s_lshl_b32 s34, s34, 17
    s_add_u32 s34, s34, s95
    buffer_load_dwordx4 v120, s[8:11], s34 offen lds
    s_add_u32 m0, s96, 17408
    s_nop 0
    buffer_load_dwordx4 v121, s[8:11], s34 offen lds
    s_waitcnt vmcnt(6)
    s_barrier
    s_add_u32 m0, s96, 24576
    s_add_u32 s34, s29, 9
    s_and_b32 s34, s34, 15
    s_lshl_b32 s34, s34, 17
    s_add_u32 s34, s34, s95
    buffer_load_dwordx4 v120, s[8:11], s34 offen lds
    s_add_u32 m0, s96, 25600
    s_nop 0
    buffer_load_dwordx4 v121, s[8:11], s34 offen lds
    s_waitcnt vmcnt(6)
    s_barrier
    s_add_u32 m0, s96, 32768
    s_add_u32 s34, s29, 10
    s_and_b32 s34, s34, 15
    s_lshl_b32 s34, s34, 17
    s_add_u32 s34, s34, s95
    buffer_load_dwordx4 v120, s[8:11], s34 offen lds
    s_add_u32 m0, s96, 33792
    s_nop 0
    buffer_load_dwordx4 v121, s[8:11], s34 offen lds
    s_waitcnt vmcnt(6)
    s_barrier
    s_add_u32 m0, s96, 40960
    s_add_u32 s34, s29, 11
    s_and_b32 s34, s34, 15
    s_lshl_b32 s34, s34, 17
    s_add_u32 s34, s34, s95
    buffer_load_dwordx4 v120, s[8:11], s34 offen lds
    s_add_u32 m0, s96, 41984
    s_nop 0
    buffer_load_dwordx4 v121, s[8:11], s34 offen lds
    s_waitcnt vmcnt(6)
    s_barrier
    s_add_u32 m0, s96, 0
    s_add_u32 s34, s29, 12
    s_and_b32 s34, s34, 15
    s_lshl_b32 s34, s34, 17
    s_add_u32 s34, s34, s95
    buffer_load_dwordx4 v120, s[8:11], s34 offen lds
    s_add_u32 m0, s96, 1024
    s_nop 0
    buffer_load_dwordx4 v121, s[8:11], s34 offen lds
    s_waitcnt vmcnt(6)
    s_barrier
    s_add_u32 m0, s96, 8192
    s_add_u32 s34, s29, 13
    s_and_b32 s34, s34, 15
    s_lshl_b32 s34, s34, 17
    s_add_u32 s34, s34, s95
    buffer_load_dwordx4 v120, s[8:11], s34 offen lds
    s_add_u32 m0, s96, 9216
    s_nop 0
    buffer_load_dwordx4 v121, s[8:11], s34 offen lds
    s_waitcnt vmcnt(6)
    s_barrier
    s_add_u32 m0, s96, 16384
    s_add_u32 s34, s29, 14
    s_and_b32 s34, s34, 15
    s_lshl_b32 s34, s34, 17
    s_add_u32 s34, s34, s95
    buffer_load_dwordx4 v120, s[8:11], s34 offen lds
    s_add_u32 m0, s96, 17408
    s_nop 0
    buffer_load_dwordx4 v121, s[8:11], s34 offen lds
    s_waitcnt vmcnt(6)
    s_barrier
    s_add_u32 m0, s96, 24576
    s_add_u32 s34, s29, 15
    s_and_b32 s34, s34, 15
    s_lshl_b32 s34, s34, 17
    s_add_u32 s34, s34, s95
    buffer_load_dwordx4 v120, s[8:11], s34 offen lds
    s_add_u32 m0, s96, 25600
    s_nop 0
    buffer_load_dwordx4 v121, s[8:11], s34 offen lds
    buffer_load_dwordx4 v[112:115], v148, s[8:11], s97 offen offset:0 sc1
    buffer_load_dwordx4 v[116:119], v148, s[8:11], s97 offen offset:2048 sc1
    s_add_u32 s97, s97, 4096
    s_waitcnt vmcnt(8)
    s_barrier
    buffer_load_dwordx4 v[120:123], v148, s[8:11], s97 offen offset:0 sc1
    buffer_load_dwordx4 v[124:127], v148, s[8:11], s97 offen offset:2048 sc1
    s_add_u32 s97, s97, 4096
    s_waitcnt vmcnt(8)
    s_barrier
    buffer_load_dwordx4 v[128:131], v148, s[8:11], s97 offen offset:0 sc1
    buffer_load_dwordx4 v[132:135], v148, s[8:11], s97 offen offset:2048 sc1
    s_add_u32 s97, s97, 4096
    s_waitcnt vmcnt(8)
    s_barrier
    buffer_load_dwordx4 v[136:139], v148, s[8:11], s97 offen offset:0 sc1
    buffer_load_dwordx4 v[140:143], v148, s[8:11], s97 offen offset:2048 sc1
    s_waitcnt vmcnt(8)
    s_barrier
    s_mov_b32 s99, 100000
    s_waitcnt vmcnt(0)
    s_branch L_lnf_63
L_lnr_61:
    s_mov_b32 s97, s94
    buffer_load_dwordx4 v[112:115], v148, s[8:11], s97 offen offset:0 sc1
    buffer_load_dwordx4 v[116:119], v148, s[8:11], s97 offen offset:2048 sc1
    s_add_u32 s97, s97, 4096
    buffer_load_dwordx4 v[120:123], v148, s[8:11], s97 offen offset:0 sc1
    buffer_load_dwordx4 v[124:127], v148, s[8:11], s97 offen offset:2048 sc1
    s_add_u32 s97, s97, 4096
    buffer_load_dwordx4 v[128:131], v148, s[8:11], s97 offen offset:0 sc1
    buffer_load_dwordx4 v[132:135], v148, s[8:11], s97 offen offset:2048 sc1
    s_add_u32 s97, s97, 4096
    buffer_load_dwordx4 v[136:139], v148, s[8:11], s97 offen offset:0 sc1
    buffer_load_dwordx4 v[140:143], v148, s[8:11], s97 offen offset:2048 sc1
    s_waitcnt vmcnt(0)
L_lnf_63:
    v_xor_b32 v2, s4, v113
    v_xor_b32 v3, s4, v115
    v_xor_b32 v4, s4, v117
    v_or3_b32 v2, v2, v3, v4
    v_xor_b32 v3, s4, v119
    v_xor_b32 v4, s4, v121
    v_or3_b32 v2, v2, v3, v4
    v_xor_b32 v3, s4, v123
    v_xor_b32 v4, s4, v125
    v_or3_b32 v2, v2, v3, v4
    v_xor_b32 v3, s4, v127
    v_xor_b32 v4, s4, v129
    v_or3_b32 v2, v2, v3, v4
    v_xor_b32 v3, s4, v131
    v_xor_b32 v4, s4, v133
    v_or3_b32 v2, v2, v3, v4
    v_xor_b32 v3, s4, v135
    v_xor_b32 v4, s4, v137
    v_or3_b32 v2, v2, v3, v4
    v_xor_b32 v3, s4, v139
    v_xor_b32 v4, s4, v141
    v_or3_b32 v2, v2, v3, v4
    v_xor_b32 v3, s4, v143
    v_or_b32 v2, v2, v3
    v_cmp_ne_u32 vcc, 0, v2
    s_cbranch_vccz L_lnk_62
    s_sub_u32 s99, s99, 1
    s_cmp_eq_u32 s99, 0
    s_cbranch_scc1 L_lnk_62
    s_sleep 1
    s_branch L_lnr_61
L_lnk_62:
    v_add_f32 v13, v112, v116
    v_add_f32 v14, v114, v118
    v_add_f32 v13, v13, v120
    v_add_f32 v14, v14, v122
    v_add_f32 v13, v13, v124
    v_add_f32 v14, v14, v126
    v_add_f32 v13, v13, v128
    v_add_f32 v14, v14, v130
    v_add_f32 v13, v13, v132
    v_add_f32 v14, v14, v134
    v_add_f32 v13, v13, v136
    v_add_f32 v14, v14, v138
    v_add_f32 v13, v13, v140
    v_add_f32 v14, v14, v142
    v_mov_b32 v2, v13
    v_mov_b32 v3, v14
    s_nop 1
    v_permlane32_swap_b32 v2, v13
    v_permlane32_swap_b32 v3, v14
    s_nop 1
    v_add_f32 v13, v13, v2
    v_add_f32 v14, v14, v3
    v_mul_f32 v13, 0x3b000000, v13
    v_mul_f32 v14, 0x3b000000, v14
    v_fma_f32 v14, -v13, v13, v14
    v_max_f32 v14, 0, v14
    v_cvt_pk_bf16_f32 v2, v13, v14
    v_lshlrev_b32 v6, 16, v2
    v_and_b32 v14, 0xffff0000, v2
    v_add_f32 v14, 0x3727c5ac, v14
    v_cvt_pk_bf16_f32 v14, v14, v14
    v_lshlrev_b32 v14, 16, v14
    v_sqrt_f32 v14, v14
    s_nop 0
    v_cvt_pk_bf16_f32 v14, v14, v14
    v_lshlrev_b32 v14, 16, v14
    v_rcp_f32 v7, v14
    v_and_b32 v2, 31, v1
    v_lshlrev_b32 v2, 3, v2
    s_lshl_b32 s74, s30, 8
    v_add_u32 v2, s74, v2
    v_add_u32 v2, 161792, v2
    s_mov_b32 exec_hi, 0
    ds_write_b64 v2, v[6:7]
    s_mov_b32 exec_hi, -1
    v_mov_b32 v8, 1
    v_mov_b32 v9, 156472
    s_waitcnt lgkmcnt(0)
    s_mov_b64 exec, 1
    ds_add_u32 v9, v8
    s_mov_b64 exec, -1
    s_branch L_H_P3_done
L_h3idle_24:
    s_barrier
    s_barrier
    s_barrier
    s_barrier
    s_barrier
    s_barrier
    s_barrier
    s_barrier
    s_barrier
    s_barrier
    s_barrier
    s_barrier
    s_barrier
    s_barrier
    s_barrier
    s_barrier
L_H_P3_done:
    s_sub_u32 s30, s3, 4
    s_lshr_b32 s74, s7, 2
    s_lshl_b32 s74, s74, 6
    s_lshl_b32 s75, s30, 4
    s_add_u32 s74, s74, s75
    s_lshl_b32 s74, s74, 12
    s_and_b32 s75, s7, 3
    s_lshl_b32 s76, s6, 2
    s_add_u32 s75, s75, s76
    s_lshl_b32 s75, s75, 7
    s_add_u32 s74, s74, s75
    s_add_u32 s74, s74, 9437184
    v_lshrrev_b32 v2, 3, v1
    v_lshlrev_b32 v2, 12, v2
    v_and_b32 v3, 7, v1
    v_lshlrev_b32 v3, 4, v3
    v_add_u32 v2, v2, v3
    s_lshl_b32 s75, s30, 11
    s_add_u32 m0, s75, 139264
    s_nop 0
    buffer_load_dwordx4 v2, s[8:11], s74 offen lds
    s_add_u32 m0, s75, 140288
    s_add_u32 s74, s74, 32768
    buffer_load_dwordx4 v2, s[8:11], s74 offen lds
    s_cmp_lg_u32 s2, 0
    s_cbranch_scc1 L_noep_64
    s_cmp_lg_u32 s3, 4
    s_cbranch_scc1 L_noep_64
    v_mov_b32 v3, s4
    v_mov_b32 v4, 0
    s_mov_b64 exec, 1
    buffer_store_dword v3, v4, s[8:11], 0 offen sc1
    s_mov_b64 exec, -1
L_noep_64:
    s_mov_b32 s99, 100000
    s_and_b32 s28, s7, 3
    s_lshl_b32 s29, s6, 2
    s_add_u32 s28, s28, s29
    s_sub_u32 s30, s3, 4
    s_cmp_lg_u32 s30, 0
    s_cbranch_scc1 L_f3w_65
    s_lshr_b32 s31, s28, 1
    s_and_b32 s32, s31, 3
    s_lshl_b32 s32, s32, 3
    s_lshr_b32 s31, s31, 2
    s_add_u32 s32, s32, s31
    s_lshl_b32 s32, s32, 4
    s_add_u32 s32, s32, 8192
    v_min_u32 v3, 14, v1
    v_and_b32 v2, 7, v3
    v_lshlrev_b32 v2, 5, v2
    v_lshrrev_b32 v3, 3, v3
    v_lshlrev_b32 v3, 2, v3
    v_add_u32 v2, v2, v3
    v_lshlrev_b32 v2, 4, v2
    s_waitcnt vmcnt(0)
    v_mov_b32 v8, 156464
    s_mov_b32 s99, 800000
L_evs_68:
    ds_read_b32 v9, v8
    s_waitcnt lgkmcnt(0)
    v_readfirstlane_b32 s79, v9
    s_cmp_ge_u32 s79, 4
    s_cbranch_scc1 L_evk_69
    s_sub_u32 s99, s99, 1
    s_cmp_eq_u32 s99, 0
    s_cbranch_scc1 L_evk_69
    s_sleep 1
    s_branch L_evs_68
L_evk_69:
    s_mov_b32 s99, 100000
L_f3r_66:
    buffer_load_dword v10, v2, s[8:11], s32 offen sc1
    s_waitcnt vmcnt(0)
    v_xor_b32 v250, s4, v10
    v_cmp_ne_u32 vcc, 0, v250
    s_cbranch_vccz L_f3k_67
    s_sub_u32 s99, s99, 1
    s_cmp_eq_u32 s99, 0
    s_cbranch_scc1 L_f3k_67
    s_sleep 1
    s_branch L_f3r_66
L_f3k_67:
L_f3w_65:
    s_barrier
    s_lshl_b32 s31, s28, 1
    s_and_b32 s32, s30, 1
    s_add_u32 s31, s31, s32
    s_mul_i32 s31, s31, 88064
    s_lshr_b32 s32, s30, 1
    s_mul_i32 s32, s32, 44032
    s_add_u32 s31, s31, s32
    s_add_u32 s31, s31, 11534336
    s_lshl_b32 s33, s30, 10
    v_lshlrev_b32 v20, 4, v1
    s_add_u32 m0, s33, 0
    s_add_u32 s34, s31, 16384
    buffer_load_dwordx4 v20, s[8:11], s34 offen lds
    s_add_u32 m0, s33, 4096
    s_add_u32 s34, s31, 17408
    buffer_load_dwordx4 v20, s[8:11], s34 offen lds
    s_add_u32 m0, s33, 8192
    s_add_u32 s34, s31, 18432
    buffer_load_dwordx4 v20, s[8:11], s34 offen lds
    s_add_u32 m0, s33, 12288
    s_add_u32 s34, s31, 19456
    buffer_load_dwordx4 v20, s[8:11], s34 offen lds
    s_add_u32 m0, s33, 16384
    s_add_u32 s34, s31, 20480
    buffer_load_dwordx4 v20, s[8:11], s34 offen lds
    s_add_u32 m0, s33, 20480
    s_add_u32 s34, s31, 21504
    buffer_load_dwordx4 v20, s[8:11], s34 offen lds
    s_add_u32 m0, s33, 24576
    s_add_u32 s34, s31, 22528
    buffer_load_dwordx4 v20, s[8:11], s34 offen lds
    s_add_u32 m0, s33, 28672
    s_add_u32 s34, s31, 23552
    buffer_load_dwordx4 v20, s[8:11], s34 offen lds
    s_waitcnt vmcnt(4)
    s_barrier
    s_add_u32 m0, s33, 32768
    s_add_u32 s34, s31, 24576
    buffer_load_dwordx4 v20, s[8:11], s34 offen lds
    s_add_u32 m0, s33, 36864
    s_add_u32 s34, s31, 25600
    buffer_load_dwordx4 v20, s[8:11], s34 offen lds
    s_add_u32 m0, s33, 40960
    s_add_u32 s34, s31, 26624
    buffer_load_dwordx4 v20, s[8:11], s34 offen lds
    s_add_u32 m0, s33, 45056
    s_add_u32 s34, s31, 27648
    buffer_load_dwordx4 v20, s[8:11], s34 offen lds
    s_add_u32 m0, s33, 49152
    s_add_u32 s34, s31, 28672
    buffer_load_dwordx4 v20, s[8:11], s34 offen lds
    s_add_u32 m0, s33, 53248
    s_add_u32 s34, s31, 29696
    buffer_load_dwordx4 v20, s[8:11], s34 offen lds
    s_add_u32 m0, s33, 57344
    s_add_u32 s34, s31, 30720
    buffer_load_dwordx4 v20, s[8:11], s34 offen lds
    s_add_u32 m0, s33, 61440
    s_add_u32 s34, s31, 31744
    buffer_load_dwordx4 v20, s[8:11], s34 offen lds
    s_waitcnt vmcnt(8)
    s_barrier
    s_add_u32 m0, s33, 65536
    s_add_u32 s34, s31, 32768
    buffer_load_dwordx4 v20, s[8:11], s34 offen lds
    s_add_u32 m0, s33, 69632
    s_add_u32 s34, s31, 33792
    buffer_load_dwordx4 v20, s[8:11], s34 offen lds
    s_add_u32 m0, s33, 73728
    s_add_u32 s34, s31, 34816
    buffer_load_dwordx4 v20, s[8:11], s34 offen lds
    s_add_u32 m0, s33, 77824
    s_add_u32 s34, s31, 35840
    buffer_load_dwordx4 v20, s[8:11], s34 offen lds
    s_add_u32 m0, s33, 81920
    s_add_u32 s34, s31, 36864
    buffer_load_dwordx4 v20, s[8:11], s34 offen lds
    s_add_u32 m0, s33, 86016
    s_add_u32 s34, s31, 37888
    buffer_load_dwordx4 v20, s[8:11], s34 offen lds
    s_add_u32 m0, s33, 90112
    s_add_u32 s34, s31, 38912
    buffer_load_dwordx4 v20, s[8:11], s34 offen lds
    s_add_u32 m0, s33, 94208
    s_add_u32 s34, s31, 39936
    buffer_load_dwordx4 v20, s[8:11], s34 offen lds
    s_waitcnt vmcnt(12)
    s_barrier
    s_add_u32 m0, s33, 98304
    s_add_u32 s34, s31, 40960
    buffer_load_dwordx4 v20, s[8:11], s34 offen lds
    s_add_u32 m0, s33, 102400
    s_add_u32 s34, s31, 41984
    buffer_load_dwordx4 v20, s[8:11], s34 offen lds
    s_add_u32 m0, s33, 106496
    s_add_u32 s34, s31, 43008
    buffer_load_dwordx4 v20, s[8:11], s34 offen lds
    s_add_u32 m0, s33, 110592
    s_add_u32 s34, s31, 0
    buffer_load_dwordx4 v20, s[8:11], s34 offen lds
    s_add_u32 m0, s33, 114688
    s_add_u32 s34, s31, 1024
    buffer_load_dwordx4 v20, s[8:11], s34 offen lds
    s_add_u32 m0, s33, 118784
    s_add_u32 s34, s31, 2048
    buffer_load_dwordx4 v20, s[8:11], s34 offen lds
    s_add_u32 m0, s33, 122880
    s_add_u32 s34, s31, 3072
    buffer_load_dwordx4 v20, s[8:11], s34 offen lds
    s_add_u32 m0, s33, 126976
    s_add_u32 s34, s31, 4096
    buffer_load_dwordx4 v20, s[8:11], s34 offen lds
    s_waitcnt vmcnt(16)
    s_barrier
    s_add_u32 m0, s33, 131072
    s_add_u32 s34, s31, 5120
    buffer_load_dwordx4 v20, s[8:11], s34 offen lds
    s_add_u32 m0, s33, 135168
    s_add_u32 s34, s31, 6144
    buffer_load_dwordx4 v20, s[8:11], s34 offen lds
    s_add_u32 m0, s33, 0
    s_add_u32 s34, s31, 7168
    buffer_load_dwordx4 v20, s[8:11], s34 offen lds
    s_add_u32 m0, s33, 4096
    s_add_u32 s34, s31, 8192
    buffer_load_dwordx4 v20, s[8:11], s34 offen lds
    s_add_u32 m0, s33, 8192
    s_add_u32 s34, s31, 9216
    buffer_load_dwordx4 v20, s[8:11], s34 offen lds
    s_waitcnt vmcnt(17)
    s_barrier
    s_add_u32 m0, s33, 12288
    s_add_u32 s34, s31, 10240
    buffer_load_dwordx4 v20, s[8:11], s34 offen lds
    s_add_u32 m0, s33, 16384
    s_add_u32 s34, s31, 11264
    buffer_load_dwordx4 v20, s[8:11], s34 offen lds
    s_add_u32 m0, s33, 20480
    s_add_u32 s34, s31, 12288
    buffer_load_dwordx4 v20, s[8:11], s34 offen lds
    s_add_u32 m0, s33, 24576
    s_add_u32 s34, s31, 13312
    buffer_load_dwordx4 v20, s[8:11], s34 offen lds
    s_add_u32 m0, s33, 28672
    s_add_u32 s34, s31, 14336
    buffer_load_dwordx4 v20, s[8:11], s34 offen lds
    s_waitcnt vmcnt(18)
    s_barrier
    s_add_u32 m0, s33, 32768
    s_add_u32 s34, s31, 15360
    buffer_load_dwordx4 v20, s[8:11], s34 offen lds
    s_waitcnt vmcnt(15)
    s_barrier
    s_waitcnt vmcnt(11)
    s_barrier
    s_waitcnt vmcnt(7)
    s_barrier
    s_waitcnt vmcnt(3)
    s_barrier
    s_waitcnt vmcnt(0)
    s_barrier
    s_barrier
    s_branch L_fin
L_M_P0:
    s_lshr_b32 s28, s3, 1
    s_lshl_b32 s29, s5, 1
    s_add_u32 s29, s29, s28
    s_and_b32 s30, s3, 1
    s_lshl_b32 s31, s29, 8
    s_lshl_b32 s32, s30, 7
    s_add_u32 s31, s31, s32
    v_lshlrev_b32 v9, 1, v1
    v_add_u32 v9, s31, v9
    s_lshl_b32 s32, s29, 1
    v_mov_b32 v16, s32
    v_mov_b32 v12, 0
    v_mov_b32 v13, 0
    v_mov_b32 v14, 0
    v_mov_b32 v15, 0
    v_lshrrev_b32 v10, 5, v1
    s_lshl_b32 s32, s3, 1
    v_add_u32 v10, s32, v10
    v_mul_u32_u24 v10, 1568, v10
    v_and_b32 v11, 31, v1
    v_lshlrev_b32 v11, 4, v11
    v_add_u32 v10, v10, v11
    v_add_u32 v10, 135168, v10
    ds_write_b128 v10, v[12:15]
    v_lshrrev_b32 v10, 3, v1
    v_mul_u32_u24 v10, 4416, v10
    v_and_b32 v11, 7, v1
    v_lshlrev_b32 v11, 4, v11
    v_add_u32 v10, v10, v11
    ds_write_b128 v10, v[12:15] offset:4080
    s_waitcnt lgkmcnt(0)
    global_load_ushort v2, v9, s[38:39]
    global_load_ushort v3, v9, s[40:41]
    global_load_ushort v4, v9, s[42:43]
    global_load_ushort v5, v9, s[44:45]
    global_load_ushort v6, v9, s[46:47]
    global_load_ushort v7, v9, s[48:49]
    global_load_ushort v8, v16, s[50:51]
    s_mov_b32 s8, s72
    s_and_b32 s9, s73, 0xffff
    s_mov_b32 s10, 268435456
    s_mov_b32 s11, 0x20000
    v_mov_b32 v253, 0
    buffer_load_dword v255, v253, s[8:11], 0 offen sc1
    s_barrier
    s_mul_i32 s33, s3, 17408
    s_add_u32 s33, s33, 35328
    v_lshlrev_b32 v60, 2, v1
    v_add_u32 v60, s33, v60
    v_add_u32 v61, 8704, v60
    s_mov_b32 s34, 1069066811
    s_mov_b32 s35, 849703008
    s_waitcnt vmcnt(0)
    v_readfirstlane_b32 s4, v255
    s_add_u32 s4, s4, 2654435769
    v_lshlrev_b32 v2, 16, v2
    v_lshlrev_b32 v3, 16, v3
    v_lshlrev_b32 v4, 16, v4
    v_lshlrev_b32 v5, 16, v5
    v_lshlrev_b32 v6, 16, v6
    v_lshlrev_b32 v7, 16, v7
    v_lshlrev_b32 v8, 16, v8
    v_mul_f32 v10, s34, v8
    v_fma_f32 v11, v8, s34, -v10
    v_fma_f32 v11, v8, s35, v11
    v_exp_f32 v10, v10
    v_mul_f32 v11, 1060205080, v11
    v_fma_f32 v10, v10, v11, v10
    v_cvt_pk_bf16_f32 v10, v10, v10
    v_lshlrev_b32 v8, 16, v10
    v_mul_f32 v2, v8, v2
    v_mul_f32 v3, v8, v3
    v_mul_f32 v4, v8, v4
    v_mul_f32 v5, v8, v5
    v_mul_f32 v10, v6, v4
    v_mul_f32 v11, v6, v5
    v_fma_f32 v10, -v7, v5, v10
    v_fma_f32 v11, v7, v4, v11
    v_mul_f32 v12, s34, v2
    v_mul_f32 v13, 1042479491, v3
    s_mov_b32 s74, 0x41000000
    s_mov_b32 s75, 0x43800000
    s_mov_b32 s76, 0x44000000
    s_mov_b32 s77, 0x44800000
    v_mul_f32 v38, s74, v12
    v_mul_f32 v41, 1.0, v12
    v_mul_f32 v44, s75, v12
    v_mul_f32 v39, s74, v13
    v_mul_f32 v42, 1.0, v13
    v_mul_f32 v45, s75, v13
    v_exp_f32 v38, v38
    v_exp_f32 v41, v41
    v_exp_f32 v44, v44
    v_fract_f32 v39, v39
    v_fract_f32 v42, v42
    v_fract_f32 v45, v45
    v_cos_f32 v40, v39
    v_cos_f32 v43, v42
    v_cos_f32 v46, v45
    v_sin_f32 v39, v39
    v_sin_f32 v42, v42
    v_sin_f32 v45, v45
    v_mul_f32 v20, v38, v40
    v_mul_f32 v14, v41, v43
    v_mul_f32 v24, v44, v46
    v_mul_f32 v21, v38, v39
    v_mul_f32 v15, v41, v42
    v_mul_f32 v25, v44, v45
    v_mul_f32 v38, s76, v12
    v_mul_f32 v41, s77, v12
    v_pk_mul_f32 v[44:45], v[20:21], v[20:21] op_sel_hi:[1,0]
    v_mul_f32 v39, s76, v13
    v_mul_f32 v42, s77, v13
    v_pk_fma_f32 v[22:23], v[20:21], v[20:21], v[44:45] op_sel:[1,1,0] op_sel_hi:[0,1,1] neg_lo:[1,0,0]
    v_exp_f32 v38, v38
    v_exp_f32 v41, v41
    v_pk_mul_f32 v[46:47], v[14:15], v[14:15] op_sel_hi:[1,0]
    v_fract_f32 v39, v39
    v_fract_f32 v42, v42
    v_pk_fma_f32 v[16:17], v[14:15], v[14:15], v[46:47] op_sel:[1,1,0] op_sel_hi:[0,1,1] neg_lo:[1,0,0]
    v_cos_f32 v40, v39
    v_cos_f32 v43, v42
    v_sin_f32 v39, v39
    v_sin_f32 v42, v42
    v_mul_f32 v26, v38, v40
    v_mul_f32 v28, v41, v43
    v_mul_f32 v27, v38, v39
    v_mul_f32 v29, v41, v42
    v_pk_mul_f32 v[44:45], v[16:17], v[16:17] op_sel_hi:[1,0]
    v_pk_fma_f32 v[18:19], v[16:17], v[16:17], v[44:45] op_sel:[1,1,0] op_sel_hi:[0,1,1] neg_lo:[1,0,0]
    v_mov_b32 v54, 0x3f80
    v_mov_b32 v32, v20
    v_cvt_pk_bf16_f32 v56, v10, v11
    ds_write_b32 v61, v54 offset:0
    v_mov_b32 v33, v21
    ds_write_b32 v60, v56 offset:0
    v_mov_b32 v30, v22
    v_cvt_pk_bf16_f32 v55, v32, -v33
    v_pk_mul_f32 v[52:53], v[10:11], v[14:15] op_sel_hi:[1,0]
    v_mov_b32 v31, v23
    ds_write_b32 v61, v55 offset:272
    v_pk_fma_f32 v[34:35], v[10:11], v[14:15], v[52:53] op_sel:[1,1,0] op_sel_hi:[0,1,1] neg_lo:[1,0,0]
    v_cvt_pk_bf16_f32 v54, v30, -v31
    v_pk_mul_f32 v[50:51], v[32:33], v[22:23] op_sel_hi:[1,0]
    v_cvt_pk_bf16_f32 v56, v34, v35
    ds_write_b32 v61, v54 offset:544
    v_pk_fma_f32 v[32:33], v[32:33], v[22:23], v[50:51] op_sel:[1,1,0] op_sel_hi:[0,1,1] neg_lo:[1,0,0]
    ds_write_b32 v60, v56 offset:272
    v_pk_mul_f32 v[48:49], v[30:31], v[22:23] op_sel_hi:[1,0]
    v_cvt_pk_bf16_f32 v55, v32, -v33
    v_pk_mul_f32 v[52:53], v[34:35], v[14:15] op_sel_hi:[1,0]
    v_pk_fma_f32 v[30:31], v[30:31], v[22:23], v[48:49] op_sel:[1,1,0] op_sel_hi:[0,1,1] neg_lo:[1,0,0]
    ds_write_b32 v61, v55 offset:816
    v_pk_fma_f32 v[34:35], v[34:35], v[14:15], v[52:53] op_sel:[1,1,0] op_sel_hi:[0,1,1] neg_lo:[1,0,0]
    v_cvt_pk_bf16_f32 v54, v30, -v31
    v_pk_mul_f32 v[50:51], v[32:33], v[22:23] op_sel_hi:[1,0]
    v_cvt_pk_bf16_f32 v56, v34, v35
    ds_write_b32 v61, v54 offset:1088
    v_pk_fma_f32 v[32:33], v[32:33], v[22:23], v[50:51] op_sel:[1,1,0] op_sel_hi:[0,1,1] neg_lo:[1,0,0]
    ds_write_b32 v60, v56 offset:544
    v_pk_mul_f32 v[48:49], v[30:31], v[22:23] op_sel_hi:[1,0]
    v_cvt_pk_bf16_f32 v55, v32, -v33
    v_pk_mul_f32 v[52:53], v[34:35], v[14:15] op_sel_hi:[1,0]
    v_pk_fma_f32 v[30:31], v[30:31], v[22:23], v[48:49] op_sel:[1,1,0] op_sel_hi:[0,1,1] neg_lo:[1,0,0]
    ds_write_b32 v61, v55 offset:1360
    v_pk_fma_f32 v[34:35], v[34:35], v[14:15], v[52:53] op_sel:[1,1,0] op_sel_hi:[0,1,1] neg_lo:[1,0,0]
    v_cvt_pk_bf16_f32 v54, v30, -v31
    v_pk_mul_f32 v[50:51], v[32:33], v[22:23] op_sel_hi:[1,0]
    v_cvt_pk_bf16_f32 v56, v34, v35
    ds_write_b32 v61, v54 offset:1632
    v_pk_fma_f32 v[32:33], v[32:33], v[22:23], v[50:51] op_sel:[1,1,0] op_sel_hi:[0,1,1] neg_lo:[1,0,0]
    ds_write_b32 v60, v56 offset:816
    v_pk_mul_f32 v[48:49], v[30:31], v[22:23] op_sel_hi:[1,0]
    v_cvt_pk_bf16_f32 v55, v32, -v33
    v_pk_mul_f32 v[52:53], v[34:35], v[14:15] op_sel_hi:[1,0]
    v_pk_fma_f32 v[30:31], v[30:31], v[22:23], v[48:49] op_sel:[1,1,0] op_sel_hi:[0,1,1] neg_lo:[1,0,0]
    ds_write_b32 v61, v55 offset:1904
    v_pk_fma_f32 v[34:35], v[34:35], v[14:15], v[52:53] op_sel:[1,1,0] op_sel_hi:[0,1,1] neg_lo:[1,0,0]
    v_cvt_pk_bf16_f32 v54, v30, -v31
    v_pk_mul_f32 v[50:51], v[32:33], v[22:23] op_sel_hi:[1,0]
    v_cvt_pk_bf16_f32 v56, v34, v35
    ds_write_b32 v61, v54 offset:2176
    v_pk_fma_f32 v[32:33], v[32:33], v[22:23], v[50:51] op_sel:[1,1,0] op_sel_hi:[0,1,1] neg_lo:[1,0,0]
    ds_write_b32 v60, v56 offset:2176
    v_pk_mul_f32 v[48:49], v[30:31], v[22:23] op_sel_hi:[1,0]
    v_cvt_pk_bf16_f32 v55, v32, -v33
    v_pk_mul_f32 v[52:53], v[34:35], v[14:15] op_sel_hi:[1,0]
    v_pk_fma_f32 v[30:31], v[30:31], v[22:23], v[48:49] op_sel:[1,1,0] op_sel_hi:[0,1,1] neg_lo:[1,0,0]
    ds_write_b32 v61, v55 offset:2448
    v_pk_fma_f32 v[34:35], v[34:35], v[14:15], v[52:53] op_sel:[1,1,0] op_sel_hi:[0,1,1] neg_lo:[1,0,0]
    v_cvt_pk_bf16_f32 v54, v30, -v31
    v_pk_mul_f32 v[50:51], v[32:33], v[22:23] op_sel_hi:[1,0]
    v_cvt_pk_bf16_f32 v56, v34, v35
    ds_write_b32 v61, v54 offset:2720
    v_pk_fma_f32 v[32:33], v[32:33], v[22:23], v[50:51] op_sel:[1,1,0] op_sel_hi:[0,1,1] neg_lo:[1,0,0]
    ds_write_b32 v60, v56 offset:2448
    v_pk_mul_f32 v[48:49], v[30:31], v[22:23] op_sel_hi:[1,0]
    v_cvt_pk_bf16_f32 v55, v32, -v33
    v_pk_mul_f32 v[52:53], v[34:35], v[14:15] op_sel_hi:[1,0]
    v_pk_fma_f32 v[30:31], v[30:31], v[22:23], v[48:49] op_sel:[1,1,0] op_sel_hi:[0,1,1] neg_lo:[1,0,0]
    ds_write_b32 v61, v55 offset:2992
    v_pk_fma_f32 v[34:35], v[34:35], v[14:15], v[52:53] op_sel:[1,1,0] op_sel_hi:[0,1,1] neg_lo:[1,0,0]
    v_cvt_pk_bf16_f32 v54, v30, -v31
    v_pk_mul_f32 v[50:51], v[32:33], v[22:23] op_sel_hi:[1,0]
    v_cvt_pk_bf16_f32 v56, v34, v35
    ds_write_b32 v61, v54 offset:3264
    v_pk_fma_f32 v[32:33], v[32:33], v[22:23], v[50:51] op_sel:[1,1,0] op_sel_hi:[0,1,1] neg_lo:[1,0,0]
    ds_write_b32 v60, v56 offset:2720
    v_pk_mul_f32 v[48:49], v[30:31], v[22:23] op_sel_hi:[1,0]
    v_cvt_pk_bf16_f32 v55, v32, -v33
    v_pk_mul_f32 v[52:53], v[34:35], v[14:15] op_sel_hi:[1,0]
    v_pk_fma_f32 v[30:31], v[30:31], v[22:23], v[48:49] op_sel:[1,1,0] op_sel_hi:[0,1,1] neg_lo:[1,0,0]
    ds_write_b32 v61, v55 offset:3536
    v_pk_fma_f32 v[34:35], v[34:35], v[14:15], v[52:53] op_sel:[1,1,0] op_sel_hi:[0,1,1] neg_lo:[1,0,0]
    v_cvt_pk_bf16_f32 v54, v30, -v31
    v_pk_mul_f32 v[50:51], v[32:33], v[22:23] op_sel_hi:[1,0]
    v_cvt_pk_bf16_f32 v56, v34, v35
    ds_write_b32 v61, v54 offset:3808
    v_pk_fma_f32 v[32:33], v[32:33], v[22:23], v[50:51] op_sel:[1,1,0] op_sel_hi:[0,1,1] neg_lo:[1,0,0]
    ds_write_b32 v60, v56 offset:2992
    v_pk_mul_f32 v[48:49], v[30:31], v[22:23] op_sel_hi:[1,0]
    v_cvt_pk_bf16_f32 v55, v32, -v33
    v_pk_mul_f32 v[52:53], v[10:11], v[24:25] op_sel_hi:[1,0]
    v_pk_fma_f32 v[30:31], v[30:31], v[22:23], v[48:49] op_sel:[1,1,0] op_sel_hi:[0,1,1] neg_lo:[1,0,0]
    ds_write_b32 v61, v55 offset:4080
    v_pk_fma_f32 v[34:35], v[10:11], v[24:25], v[52:53] op_sel:[1,1,0] op_sel_hi:[0,1,1] neg_lo:[1,0,0]
    v_cvt_pk_bf16_f32 v54, v30, -v31
    v_pk_mul_f32 v[50:51], v[32:33], v[22:23] op_sel_hi:[1,0]
    v_cvt_pk_bf16_f32 v56, v34, v35
    ds_write_b32 v61, v54 offset:4352
    v_pk_fma_f32 v[32:33], v[32:33], v[22:23], v[50:51] op_sel:[1,1,0] op_sel_hi:[0,1,1] neg_lo:[1,0,0]
    ds_write_b32 v60, v56 offset:1088
    v_pk_mul_f32 v[48:49], v[30:31], v[22:23] op_sel_hi:[1,0]
    v_cvt_pk_bf16_f32 v55, v32, -v33
    ds_write_b32 v60, v56 offset:1360
    v_pk_fma_f32 v[30:31], v[30:31], v[22:23], v[48:49] op_sel:[1,1,0] op_sel_hi:[0,1,1] neg_lo:[1,0,0]
    ds_write_b32 v61, v55 offset:4624
    v_pk_mul_f32 v[52:53], v[34:35], v[20:21] op_sel_hi:[1,0]
    v_cvt_pk_bf16_f32 v54, v30, -v31
    v_pk_mul_f32 v[50:51], v[32:33], v[22:23] op_sel_hi:[1,0]
    v_pk_fma_f32 v[36:37], v[34:35], v[20:21], v[52:53] op_sel:[1,1,0] op_sel_hi:[0,1,1] neg_lo:[1,0,0]
    ds_write_b32 v61, v54 offset:4896
    v_pk_fma_f32 v[32:33], v[32:33], v[22:23], v[50:51] op_sel:[1,1,0] op_sel_hi:[0,1,1] neg_lo:[1,0,0]
    v_cvt_pk_bf16_f32 v56, v36, v37
    v_pk_mul_f32 v[48:49], v[30:31], v[22:23] op_sel_hi:[1,0]
    v_cvt_pk_bf16_f32 v55, v32, -v33
    ds_write_b32 v60, v56 offset:4080
    v_pk_fma_f32 v[30:31], v[30:31], v[22:23], v[48:49] op_sel:[1,1,0] op_sel_hi:[0,1,1] neg_lo:[1,0,0]
    ds_write_b32 v61, v55 offset:5168
    v_pk_mul_f32 v[52:53], v[34:35], v[16:17] op_sel_hi:[1,0]
    v_cvt_pk_bf16_f32 v54, v30, -v31
    v_pk_mul_f32 v[50:51], v[32:33], v[22:23] op_sel_hi:[1,0]
    v_pk_fma_f32 v[34:35], v[34:35], v[16:17], v[52:53] op_sel:[1,1,0] op_sel_hi:[0,1,1] neg_lo:[1,0,0]
    ds_write_b32 v61, v54 offset:5440
    v_pk_fma_f32 v[32:33], v[32:33], v[22:23], v[50:51] op_sel:[1,1,0] op_sel_hi:[0,1,1] neg_lo:[1,0,0]
    v_cvt_pk_bf16_f32 v56, v34, v35
    v_pk_mul_f32 v[48:49], v[30:31], v[22:23] op_sel_hi:[1,0]
    v_cvt_pk_bf16_f32 v55, v32, -v33
    ds_write_b32 v60, v56 offset:1632
    v_pk_fma_f32 v[30:31], v[30:31], v[22:23], v[48:49] op_sel:[1,1,0] op_sel_hi:[0,1,1] neg_lo:[1,0,0]
    ds_write_b32 v61, v55 offset:5712
    v_pk_mul_f32 v[52:53], v[34:35], v[16:17] op_sel_hi:[1,0]
    v_cvt_pk_bf16_f32 v54, v30, -v31
    v_pk_mul_f32 v[50:51], v[32:33], v[22:23] op_sel_hi:[1,0]
    v_pk_fma_f32 v[34:35], v[34:35], v[16:17], v[52:53] op_sel:[1,1,0] op_sel_hi:[0,1,1] neg_lo:[1,0,0]
    ds_write_b32 v61, v54 offset:5984
    v_pk_fma_f32 v[32:33], v[32:33], v[22:23], v[50:51] op_sel:[1,1,0] op_sel_hi:[0,1,1] neg_lo:[1,0,0]
    v_cvt_pk_bf16_f32 v56, v34, v35
    v_pk_mul_f32 v[48:49], v[30:31], v[22:23] op_sel_hi:[1,0]
    v_cvt_pk_bf16_f32 v55, v32, -v33
    ds_write_b32 v60, v56 offset:1904
    v_pk_fma_f32 v[30:31], v[30:31], v[22:23], v[48:49] op_sel:[1,1,0] op_sel_hi:[0,1,1] neg_lo:[1,0,0]
    ds_write_b32 v61, v55 offset:6256
    ds_write_b32 v60, v56 offset:3264
    v_cvt_pk_bf16_f32 v54, v30, -v31
    v_pk_mul_f32 v[50:51], v[32:33], v[22:23] op_sel_hi:[1,0]
    ds_write_b32 v60, v56 offset:3536
    ds_write_b32 v61, v54 offset:6528
    v_pk_fma_f32 v[32:33], v[32:33], v[22:23], v[50:51] op_sel:[1,1,0] op_sel_hi:[0,1,1] neg_lo:[1,0,0]
    v_pk_mul_f32 v[52:53], v[34:35], v[16:17] op_sel_hi:[1,0]
    v_pk_mul_f32 v[48:49], v[30:31], v[22:23] op_sel_hi:[1,0]
    v_cvt_pk_bf16_f32 v55, v32, -v33
    v_pk_fma_f32 v[34:35], v[34:35], v[16:17], v[52:53] op_sel:[1,1,0] op_sel_hi:[0,1,1] neg_lo:[1,0,0]
    v_pk_fma_f32 v[30:31], v[30:31], v[22:23], v[48:49] op_sel:[1,1,0] op_sel_hi:[0,1,1] neg_lo:[1,0,0]
    ds_write_b32 v61, v55 offset:6800
    v_cvt_pk_bf16_f32 v56, v34, v35
    v_cvt_pk_bf16_f32 v54, v30, -v31
    v_pk_mul_f32 v[50:51], v[32:33], v[22:23] op_sel_hi:[1,0]
    ds_write_b32 v60, v56 offset:3808
    ds_write_b32 v61, v54 offset:7072
    v_pk_fma_f32 v[32:33], v[32:33], v[22:23], v[50:51] op_sel:[1,1,0] op_sel_hi:[0,1,1] neg_lo:[1,0,0]
    v_pk_mul_f32 v[52:53], v[10:11], v[26:27] op_sel_hi:[1,0]
    v_pk_mul_f32 v[48:49], v[30:31], v[22:23] op_sel_hi:[1,0]
    v_cvt_pk_bf16_f32 v55, v32, -v33
    v_pk_fma_f32 v[34:35], v[10:11], v[26:27], v[52:53] op_sel:[1,1,0] op_sel_hi:[0,1,1] neg_lo:[1,0,0]
    v_pk_fma_f32 v[30:31], v[30:31], v[22:23], v[48:49] op_sel:[1,1,0] op_sel_hi:[0,1,1] neg_lo:[1,0,0]
    ds_write_b32 v61, v55 offset:7344
    v_cvt_pk_bf16_f32 v56, v34, v35
    v_cvt_pk_bf16_f32 v54, v30, -v31
    v_pk_mul_f32 v[50:51], v[32:33], v[22:23] op_sel_hi:[1,0]
    ds_write_b32 v60, v56 offset:4352
    ds_write_b32 v61, v54 offset:7616
    v_pk_fma_f32 v[32:33], v[32:33], v[22:23], v[50:51] op_sel:[1,1,0] op_sel_hi:[0,1,1] neg_lo:[1,0,0]
    v_pk_mul_f32 v[52:53], v[34:35], v[18:19] op_sel_hi:[1,0]
    v_pk_mul_f32 v[48:49], v[30:31], v[22:23] op_sel_hi:[1,0]
    v_cvt_pk_bf16_f32 v55, v32, -v33
    v_pk_fma_f32 v[36:37], v[34:35], v[18:19], v[52:53] op_sel:[1,1,0] op_sel_hi:[0,1,1] neg_lo:[1,0,0]
    v_pk_fma_f32 v[30:31], v[30:31], v[22:23], v[48:49] op_sel:[1,1,0] op_sel_hi:[0,1,1] neg_lo:[1,0,0]
    ds_write_b32 v61, v55 offset:7888
    v_cvt_pk_bf16_f32 v56, v36, v37
    v_cvt_pk_bf16_f32 v54, v30, -v31
    v_pk_mul_f32 v[50:51], v[32:33], v[22:23] op_sel_hi:[1,0]
    ds_write_b32 v60, v56 offset:4624
    ds_write_b32 v61, v54 offset:8160
    v_pk_fma_f32 v[32:33], v[32:33], v[22:23], v[50:51] op_sel:[1,1,0] op_sel_hi:[0,1,1] neg_lo:[1,0,0]
    v_pk_mul_f32 v[52:53], v[34:35], v[20:21] op_sel_hi:[1,0]
    v_cvt_pk_bf16_f32 v55, v32, -v33
    v_pk_fma_f32 v[36:37], v[34:35], v[20:21], v[52:53] op_sel:[1,1,0] op_sel_hi:[0,1,1] neg_lo:[1,0,0]
    ds_write_b32 v61, v55 offset:8432
    v_cvt_pk_bf16_f32 v56, v36, v37
    ds_write_b32 v60, v56 offset:4896
    v_pk_mul_f32 v[52:53], v[34:35], v[24:25] op_sel_hi:[1,0]
    v_pk_fma_f32 v[34:35], v[34:35], v[24:25], v[52:53] op_sel:[1,1,0] op_sel_hi:[0,1,1] neg_lo:[1,0,0]
    v_cvt_pk_bf16_f32 v56, v34, v35
    ds_write_b32 v60, v56 offset:5440
    v_pk_mul_f32 v[52:53], v[34:35], v[18:19] op_sel_hi:[1,0]
    v_pk_fma_f32 v[36:37], v[34:35], v[18:19], v[52:53] op_sel:[1,1,0] op_sel_hi:[0,1,1] neg_lo:[1,0,0]
    v_cvt_pk_bf16_f32 v56, v36, v37
    ds_write_b32 v60, v56 offset:5712
    v_pk_mul_f32 v[52:53], v[34:35], v[20:21] op_sel_hi:[1,0]
    v_pk_fma_f32 v[36:37], v[34:35], v[20:21], v[52:53] op_sel:[1,1,0] op_sel_hi:[0,1,1] neg_lo:[1,0,0]
    v_cvt_pk_bf16_f32 v56, v36, v37
    ds_write_b32 v60, v56 offset:5984
    v_pk_mul_f32 v[52:53], v[10:11], v[28:29] op_sel_hi:[1,0]
    v_pk_fma_f32 v[34:35], v[10:11], v[28:29], v[52:53] op_sel:[1,1,0] op_sel_hi:[0,1,1] neg_lo:[1,0,0]
    v_cvt_pk_bf16_f32 v56, v34, v35
    ds_write_b32 v60, v56 offset:5168
    v_pk_mul_f32 v[52:53], v[34:35], v[20:21] op_sel_hi:[1,0]
    v_pk_fma_f32 v[36:37], v[34:35], v[20:21], v[52:53] op_sel:[1,1,0] op_sel_hi:[0,1,1] neg_lo:[1,0,0]
    v_cvt_pk_bf16_f32 v56, v36, v37
    ds_write_b32 v60, v56 offset:6528
    v_pk_mul_f32 v[52:53], v[34:35], v[24:25] op_sel_hi:[1,0]
    v_pk_fma_f32 v[58:59], v[34:35], v[24:25], v[52:53] op_sel:[1,1,0] op_sel_hi:[0,1,1] neg_lo:[1,0,0]
    v_cvt_pk_bf16_f32 v56, v58, v59
    ds_write_b32 v60, v56 offset:6800
    v_pk_mul_f32 v[52:53], v[58:59], v[20:21] op_sel_hi:[1,0]
    v_pk_fma_f32 v[36:37], v[58:59], v[20:21], v[52:53] op_sel:[1,1,0] op_sel_hi:[0,1,1] neg_lo:[1,0,0]
    v_cvt_pk_bf16_f32 v56, v36, v37
    ds_write_b32 v60, v56 offset:7072
    v_pk_mul_f32 v[52:53], v[34:35], v[26:27] op_sel_hi:[1,0]
    v_pk_fma_f32 v[34:35], v[34:35], v[26:27], v[52:53] op_sel:[1,1,0] op_sel_hi:[0,1,1] neg_lo:[1,0,0]
    v_cvt_pk_bf16_f32 v56, v34, v35
    ds_write_b32 v60, v56 offset:6256
    v_pk_mul_f32 v[52:53], v[34:35], v[20:21] op_sel_hi:[1,0]
    v_pk_fma_f32 v[36:37], v[34:35], v[20:21], v[52:53] op_sel:[1,1,0] op_sel_hi:[0,1,1] neg_lo:[1,0,0]
    v_cvt_pk_bf16_f32 v56, v36, v37
    ds_write_b32 v60, v56 offset:7616
    v_pk_mul_f32 v[52:53], v[34:35], v[24:25] op_sel_hi:[1,0]
    v_pk_fma_f32 v[34:35], v[34:35], v[24:25], v[52:53] op_sel:[1,1,0] op_sel_hi:[0,1,1] neg_lo:[1,0,0]
    v_cvt_pk_bf16_f32 v56, v34, v35
    ds_write_b32 v60, v56 offset:7888
    v_pk_mul_f32 v[52:53], v[34:35], v[20:21] op_sel_hi:[1,0]
    v_pk_fma_f32 v[36:37], v[34:35], v[20:21], v[52:53] op_sel:[1,1,0] op_sel_hi:[0,1,1] neg_lo:[1,0,0]
    v_cvt_pk_bf16_f32 v56, v36, v37
    ds_write_b32 v60, v56 offset:8160
    v_and_b32 v62, 31, v1
    v_mul_u32_u24 v62, 272, v62
    v_lshrrev_b32 v63, 5, v1
    v_lshlrev_b32 v63, 4, v63
    v_add3_u32 v62, v62, v63, s33
    v_add_u32 v63, 8704, v62
    s_waitcnt lgkmcnt(0)
    ds_read_b128 v[64:67], v62 offset:0
    ds_read_b128 v[68:71], v63 offset:0
    ds_read_b128 v[72:75], v62 offset:32
    ds_read_b128 v[76:79], v63 offset:32
    ds_read_b128 v[80:83], v62 offset:64
    ds_read_b128 v[84:87], v63 offset:64
    ds_read_b128 v[88:91], v62 offset:96
    ds_read_b128 v[92:95], v63 offset:96
    ds_read_b128 v[96:99], v62 offset:128
    ds_read_b128 v[100:103], v63 offset:128
    ds_read_b128 v[104:107], v62 offset:160
    ds_read_b128 v[108:111], v63 offset:160
    ds_read_b128 v[112:115], v62 offset:192
    ds_read_b128 v[116:119], v63 offset:192
    s_waitcnt lgkmcnt(12)
    v_mfma_f32_32x32x16_bf16 v[128:143], v[64:67], v[68:71], 0
    ds_read_b128 v[120:123], v62 offset:224
    ds_read_b128 v[124:127], v63 offset:224
    s_waitcnt lgkmcnt(12)
    v_mfma_f32_32x32x16_bf16 v[128:143], v[72:75], v[76:79], v[128:143]
    s_waitcnt lgkmcnt(10)
    v_mfma_f32_32x32x16_bf16 v[128:143], v[80:83], v[84:87], v[128:143]
    s_waitcnt lgkmcnt(8)
    v_mfma_f32_32x32x16_bf16 v[128:143], v[88:91], v[92:95], v[128:143]
    s_waitcnt lgkmcnt(6)
    v_mfma_f32_32x32x16_bf16 v[128:143], v[96:99], v[100:103], v[128:143]
    s_waitcnt lgkmcnt(4)
    v_mfma_f32_32x32x16_bf16 v[128:143], v[104:107], v[108:111], v[128:143]
    s_waitcnt lgkmcnt(2)
    v_mfma_f32_32x32x16_bf16 v[128:143], v[112:115], v[116:119], v[128:143]
    s_waitcnt lgkmcnt(0)
    v_mfma_f32_32x32x16_bf16 v[128:143], v[120:123], v[124:127], v[128:143]
    s_lshl_b32 s34, s3, 12
    s_add_u32 s34, s34, 104960
    v_lshlrev_b32 v62, 4, v1
    v_add_u32 v63, s34, v62
    s_xor_b32 s35, s34, 4096
    v_add_u32 v62, s35, v62
    s_nop 5
    ds_write_b128 v63, v[128:131] offset:0
    ds_write_b128 v63, v[132:135] offset:1024
    ds_write_b128 v63, v[136:139] offset:2048
    ds_write_b128 v63, v[140:143] offset:3072
    s_xor_b32 s35, s3, 1
    s_lshl_b32 s35, s35, 12
    s_add_u32 s35, s35, 104960
    v_lshlrev_b32 v62, 4, v1
    v_add_u32 v62, s35, v62
    s_waitcnt lgkmcnt(0)
    v_mov_b32 v7, 1
    v_mov_b32 v8, 156428
    s_waitcnt lgkmcnt(0)
    s_mov_b64 exec, 1
    ds_add_u32 v8, v7
    s_mov_b64 exec, -1
    v_mov_b32 v8, 156428
    s_mov_b32 s99, 800000
L_evs_70:
    ds_read_b32 v9, v8
    s_waitcnt lgkmcnt(0)
    v_readfirstlane_b32 s79, v9
    s_cmp_ge_u32 s79, 4
    s_cbranch_scc1 L_evk_71
    s_sub_u32 s99, s99, 1
    s_cmp_eq_u32 s99, 0
    s_cbranch_scc1 L_evk_71
    s_sleep 1
    s_branch L_evs_70
L_evk_71:
    ds_read_b128 v[64:67], v62 offset:0
    ds_read_b128 v[68:71], v62 offset:1024
    ds_read_b128 v[72:75], v62 offset:2048
    ds_read_b128 v[76:79], v62 offset:3072
    s_lshr_b32 s28, s3, 1
    s_mul_i32 s28, s28, 17664
    s_add_u32 s28, s28, 4088
    v_and_b32 v2, 31, v1
    v_lshlrev_b32 v2, 4, v2
    v_sub_u32 v2, s28, v2
    v_lshrrev_b32 v3, 5, v1
    s_mov_b32 s30, 0xaaaaaaaa
    s_mov_b32 s31, 0xaaaaaaaa
    s_waitcnt lgkmcnt(0)
    v_add_f32 v128, v128, v64
    v_add_f32 v129, v129, v65
    v_add_f32 v130, v130, v66
    v_add_f32 v131, v131, v67
    v_add_f32 v132, v132, v68
    v_add_f32 v133, v133, v69
    v_add_f32 v134, v134, v70
    v_add_f32 v135, v135, v71
    v_add_f32 v136, v136, v72
    v_add_f32 v137, v137, v73
    v_add_f32 v138, v138, v74
    v_add_f32 v139, v139, v75
    v_add_f32 v140, v140, v76
    v_add_f32 v141, v141, v77
    v_add_f32 v142, v142, v78
    v_add_f32 v143, v143, v79
    s_bitcmp1_b32 s3, 0
    s_cbranch_scc1 L_kodd_72
    v_mul_u32_u24 v4, 512, v3
    v_add_u32 v4, 0, v4
    v_sub_u32 v4, v2, v4
    v_add_u32 v5, 4416, v4
    v_add_u32 v6, 8832, v4
    v_add_u32 v7, 13248, v4
    v_cvt_pk_bf16_f32 v84, v135, v134
    v_cvt_pk_bf16_f32 v85, v133, v132
    v_cvt_pk_bf16_f32 v86, v131, v130
    v_cvt_pk_bf16_f32 v87, v129, v128
    v_cvt_pk_bf16_f32 v88, v134, v133
    v_cvt_pk_bf16_f32 v89, v132, v131
    v_cvt_pk_bf16_f32 v90, v130, v129
    ds_write_b128 v4, v[84:87] offset:8
    ds_write2_b32 v6, v84, v85 offset0:1 offset1:2
    ds_write2_b32 v6, v86, v87 offset0:3 offset1:4
    ds_write_b16 v5, v84 offset:6
    ds_write_b96 v5, v[88:90] offset:8
    ds_write_b16_d16_hi v5, v87 offset:20
    ds_write_b16 v7, v84 offset:2
    ds_write2_b32 v7, v88, v89 offset0:1 offset1:2
    ds_write_b32 v7, v90 offset:12
    ds_write_b16_d16_hi v7, v87 offset:16
    v_cndmask_b32 v8, v139, v140, s[30:31]
    v_mul_u32_u24 v4, 1024, v3
    v_add_u32 v4, 2048, v4
    v_sub_u32 v4, v2, v4
    v_add_u32 v5, 4416, v4
    v_add_u32 v6, 8832, v4
    v_add_u32 v7, 13248, v4
    v_cvt_pk_bf16_f32 v84, v140, v140
    v_cvt_pk_bf16_f32 v85, v140, v8
    v_cvt_pk_bf16_f32 v86, v139, v139
    v_cvt_pk_bf16_f32 v87, v139, v139
    v_cvt_pk_bf16_f32 v88, v140, v140
    v_cvt_pk_bf16_f32 v89, v8, v139
    v_cvt_pk_bf16_f32 v90, v139, v139
    ds_write_b128 v4, v[84:87] offset:8
    ds_write2_b32 v6, v84, v85 offset0:1 offset1:2
    ds_write2_b32 v6, v86, v87 offset0:3 offset1:4
    ds_write_b16 v5, v84 offset:6
    ds_write_b96 v5, v[88:90] offset:8
    ds_write_b16_d16_hi v5, v87 offset:20
    ds_write_b16 v7, v84 offset:2
    ds_write2_b32 v7, v88, v89 offset0:1 offset1:2
    ds_write_b32 v7, v90 offset:12
    ds_write_b16_d16_hi v7, v87 offset:16
    s_branch L_kend_73
L_kodd_72:
    v_mul_u32_u24 v4, 512, v3
    v_add_u32 v4, 1024, v4
    v_sub_u32 v4, v2, v4
    v_add_u32 v5, 4416, v4
    v_add_u32 v6, 8832, v4
    v_add_u32 v7, 13248, v4
    v_cvt_pk_bf16_f32 v84, v138, v138
    v_cvt_pk_bf16_f32 v85, v137, v137
    v_cvt_pk_bf16_f32 v86, v137, v136
    v_cvt_pk_bf16_f32 v87, v136, v136
    v_cvt_pk_bf16_f32 v88, v138, v137
    v_cvt_pk_bf16_f32 v89, v137, v137
    v_cvt_pk_bf16_f32 v90, v136, v136
    ds_write_b128 v4, v[84:87] offset:8
    ds_write2_b32 v6, v84, v85 offset0:1 offset1:2
    ds_write2_b32 v6, v86, v87 offset0:3 offset1:4
    ds_write_b16 v5, v84 offset:6
    ds_write_b96 v5, v[88:90] offset:8
    ds_write_b16_d16_hi v5, v87 offset:20
    ds_write_b16 v7, v84 offset:2
    ds_write2_b32 v7, v88, v89 offset0:1 offset1:2
    ds_write_b32 v7, v90 offset:12
    ds_write_b16_d16_hi v7, v87 offset:16
    v_cndmask_b32 v8, v141, v142, s[30:31]
    v_mul_u32_u24 v4, 1024, v3
    v_add_u32 v4, 2560, v4
    v_sub_u32 v4, v2, v4
    v_add_u32 v5, 4416, v4
    v_add_u32 v6, 8832, v4
    v_add_u32 v7, 13248, v4
    v_cvt_pk_bf16_f32 v84, v142, v142
    v_cvt_pk_bf16_f32 v85, v142, v8
    v_cvt_pk_bf16_f32 v86, v141, v141
    v_cvt_pk_bf16_f32 v87, v141, v141
    v_cvt_pk_bf16_f32 v88, v142, v142
    v_cvt_pk_bf16_f32 v89, v8, v141
    v_cvt_pk_bf16_f32 v90, v141, v141
    ds_write_b128 v4, v[84:87] offset:8
    ds_write2_b32 v6, v84, v85 offset0:1 offset1:2
    ds_write2_b32 v6, v86, v87 offset0:3 offset1:4
    ds_write_b16 v5, v84 offset:6
    ds_write_b96 v5, v[88:90] offset:8
    ds_write_b16_d16_hi v5, v87 offset:20
    ds_write_b16 v7, v84 offset:2
    ds_write2_b32 v7, v88, v89 offset0:1 offset1:2
    ds_write_b32 v7, v90 offset:12
    ds_write_b16_d16_hi v7, v87 offset:16
L_kend_73:
    s_waitcnt lgkmcnt(0)
    s_lshr_b32 s28, s3, 1
    s_and_b32 s29, s3, 1
    v_and_b32 v2, 31, v1
    v_lshrrev_b32 v3, 5, v1
    v_sub_u32 v4, 3, v2
    v_and_b32 v4, 3, v4
    v_mul_u32_u24 v5, 4416, v4
    v_lshlrev_b32 v6, 3, v3
    v_sub_u32 v6, v6, v2
    v_sub_u32 v6, v6, v4
    v_add_u32 v6, 2047, v6
    v_lshlrev_b32 v6, 1, v6
    s_mul_i32 s30, s28, 17664
    s_mul_i32 s31, s29, 1024
    s_sub_u32 s30, s30, s31
    s_add_u32 s30, s30, -2992
    v_add3_u32 v10, v5, v6, s30
    v_mul_u32_u24 v5, 1568, v3
    v_lshlrev_b32 v6, 4, v2
    s_mul_i32 s30, s28, 6272
    s_lshl_b32 s31, s29, 8
    s_sub_u32 s30, s30, s31
    s_add_u32 s30, s30, 135440
    v_add3_u32 v11, v5, v6, s30
    s_lshl_b32 s34, s5, 2
    v_mov_b32 v137, s34
    global_load_dword v136, v137, s[52:53]
    s_barrier
    ds_read_b64 v[48:49], v10 offset:3040
    ds_read_b64 v[50:51], v10 offset:3048
    ds_read_b128 v[56:59], v11 offset:3376
    ds_read_b128 v[60:63], v11 offset:3888
    ds_read_b64 v[52:53], v10 offset:992
    ds_read_b64 v[54:55], v10 offset:1000
    ds_read_b64 v[64:65], v10 offset:3008
    ds_read_b64 v[66:67], v10 offset:3016
    ds_read_b128 v[72:75], v11 offset:240
    ds_read_b128 v[76:79], v11 offset:752
    ds_read_b64 v[68:69], v10 offset:960
    ds_read_b64 v[70:71], v10 offset:968
    s_waitcnt lgkmcnt(6)
    v_mfma_f32_32x32x16_bf16 v[16:31], v[48:51], v[56:59], 0
    ds_read_b64 v[80:81], v10 offset:2976
    ds_read_b64 v[82:83], v10 offset:2984
    v_mfma_f32_32x32x16_bf16 v[32:47], v[48:51], v[60:63], 0
    ds_read_b128 v[88:91], v11 offset:3360
    ds_read_b128 v[92:95], v11 offset:3872
    v_mfma_f32_32x32x16_bf16 v[32:47], v[52:55], v[56:59], v[32:47]
    ds_read_b64 v[84:85], v10 offset:928
    ds_read_b64 v[86:87], v10 offset:936
    s_waitcnt lgkmcnt(6)
    v_mfma_f32_32x32x16_bf16 v[16:31], v[64:67], v[72:75], v[16:31]
    ds_read_b64 v[48:49], v10 offset:2944
    ds_read_b64 v[50:51], v10 offset:2952
    v_mfma_f32_32x32x16_bf16 v[32:47], v[64:67], v[76:79], v[32:47]
    ds_read_b128 v[56:59], v11 offset:224
    ds_read_b128 v[60:63], v11 offset:736
    v_mfma_f32_32x32x16_bf16 v[32:47], v[68:71], v[72:75], v[32:47]
    ds_read_b64 v[52:53], v10 offset:896
    ds_read_b64 v[54:55], v10 offset:904
    s_waitcnt lgkmcnt(6)
    v_mfma_f32_32x32x16_bf16 v[16:31], v[80:83], v[88:91], v[16:31]
    ds_read_b64 v[64:65], v10 offset:2912
    ds_read_b64 v[66:67], v10 offset:2920
    v_mfma_f32_32x32x16_bf16 v[32:47], v[80:83], v[92:95], v[32:47]
    ds_read_b128 v[72:75], v11 offset:3344
    ds_read_b128 v[76:79], v11 offset:3856
    v_mfma_f32_32x32x16_bf16 v[32:47], v[84:87], v[88:91], v[32:47]
    ds_read_b64 v[68:69], v10 offset:864
    ds_read_b64 v[70:71], v10 offset:872
    s_waitcnt lgkmcnt(6)
    v_mfma_f32_32x32x16_bf16 v[16:31], v[48:51], v[56:59], v[16:31]
    ds_read_b64 v[80:81], v10 offset:2880
    ds_read_b64 v[82:83], v10 offset:2888
    v_mfma_f32_32x32x16_bf16 v[32:47], v[48:51], v[60:63], v[32:47]
    ds_read_b128 v[88:91], v11 offset:208
    ds_read_b128 v[92:95], v11 offset:720
    v_mfma_f32_32x32x16_bf16 v[32:47], v[52:55], v[56:59], v[32:47]
    ds_read_b64 v[84:85], v10 offset:832
    ds_read_b64 v[86:87], v10 offset:840
    s_waitcnt lgkmcnt(6)
    v_mfma_f32_32x32x16_bf16 v[16:31], v[64:67], v[72:75], v[16:31]
    ds_read_b64 v[48:49], v10 offset:2848
    ds_read_b64 v[50:51], v10 offset:2856
    v_mfma_f32_32x32x16_bf16 v[32:47], v[64:67], v[76:79], v[32:47]
    ds_read_b128 v[56:59], v11 offset:3328
    ds_read_b128 v[60:63], v11 offset:3840
    v_mfma_f32_32x32x16_bf16 v[32:47], v[68:71], v[72:75], v[32:47]
    ds_read_b64 v[52:53], v10 offset:800
    ds_read_b64 v[54:55], v10 offset:808
    s_waitcnt lgkmcnt(6)
    v_mfma_f32_32x32x16_bf16 v[16:31], v[80:83], v[88:91], v[16:31]
    ds_read_b64 v[64:65], v10 offset:2816
    ds_read_b64 v[66:67], v10 offset:2824
    v_mfma_f32_32x32x16_bf16 v[32:47], v[80:83], v[92:95], v[32:47]
    ds_read_b128 v[72:75], v11 offset:192
    ds_read_b128 v[76:79], v11 offset:704
    v_mfma_f32_32x32x16_bf16 v[32:47], v[84:87], v[88:91], v[32:47]
    ds_read_b64 v[68:69], v10 offset:768
    ds_read_b64 v[70:71], v10 offset:776
    s_waitcnt lgkmcnt(6)
    v_mfma_f32_32x32x16_bf16 v[16:31], v[48:51], v[56:59], v[16:31]
    ds_read_b64 v[80:81], v10 offset:2784
    ds_read_b64 v[82:83], v10 offset:2792
    v_mfma_f32_32x32x16_bf16 v[32:47], v[48:51], v[60:63], v[32:47]
    ds_read_b128 v[88:91], v11 offset:3312
    ds_read_b128 v[92:95], v11 offset:3824
    v_mfma_f32_32x32x16_bf16 v[32:47], v[52:55], v[56:59], v[32:47]
    ds_read_b64 v[84:85], v10 offset:736
    ds_read_b64 v[86:87], v10 offset:744
    s_waitcnt lgkmcnt(6)
    v_mfma_f32_32x32x16_bf16 v[16:31], v[64:67], v[72:75], v[16:31]
    ds_read_b64 v[48:49], v10 offset:2752
    ds_read_b64 v[50:51], v10 offset:2760
    v_mfma_f32_32x32x16_bf16 v[32:47], v[64:67], v[76:79], v[32:47]
    ds_read_b128 v[56:59], v11 offset:176
    ds_read_b128 v[60:63], v11 offset:688
    v_mfma_f32_32x32x16_bf16 v[32:47], v[68:71], v[72:75], v[32:47]
    ds_read_b64 v[52:53], v10 offset:704
    ds_read_b64 v[54:55], v10 offset:712
    s_waitcnt lgkmcnt(6)
    v_mfma_f32_32x32x16_bf16 v[16:31], v[80:83], v[88:91], v[16:31]
    ds_read_b64 v[64:65], v10 offset:2720
    ds_read_b64 v[66:67], v10 offset:2728
    v_mfma_f32_32x32x16_bf16 v[32:47], v[80:83], v[92:95], v[32:47]
    ds_read_b128 v[72:75], v11 offset:3296
    ds_read_b128 v[76:79], v11 offset:3808
    v_mfma_f32_32x32x16_bf16 v[32:47], v[84:87], v[88:91], v[32:47]
    ds_read_b64 v[68:69], v10 offset:672
    ds_read_b64 v[70:71], v10 offset:680
    s_waitcnt lgkmcnt(6)
    v_mfma_f32_32x32x16_bf16 v[16:31], v[48:51], v[56:59], v[16:31]
    ds_read_b64 v[80:81], v10 offset:2688
    ds_read_b64 v[82:83], v10 offset:2696
    v_mfma_f32_32x32x16_bf16 v[32:47], v[48:51], v[60:63], v[32:47]
    ds_read_b128 v[88:91], v11 offset:160
    ds_read_b128 v[92:95], v11 offset:672
    v_mfma_f32_32x32x16_bf16 v[32:47], v[52:55], v[56:59], v[32:47]
    ds_read_b64 v[84:85], v10 offset:640
    ds_read_b64 v[86:87], v10 offset:648
    s_waitcnt lgkmcnt(6)
    v_mfma_f32_32x32x16_bf16 v[16:31], v[64:67], v[72:75], v[16:31]
    ds_read_b64 v[48:49], v10 offset:2656
    ds_read_b64 v[50:51], v10 offset:2664
    v_mfma_f32_32x32x16_bf16 v[32:47], v[64:67], v[76:79], v[32:47]
    ds_read_b128 v[56:59], v11 offset:3280
    ds_read_b128 v[60:63], v11 offset:3792
    v_mfma_f32_32x32x16_bf16 v[32:47], v[68:71], v[72:75], v[32:47]
    ds_read_b64 v[52:53], v10 offset:608
    ds_read_b64 v[54:55], v10 offset:616
    s_waitcnt lgkmcnt(6)
    v_mfma_f32_32x32x16_bf16 v[16:31], v[80:83], v[88:91], v[16:31]
    ds_read_b64 v[64:65], v10 offset:2624
    ds_read_b64 v[66:67], v10 offset:2632
    v_mfma_f32_32x32x16_bf16 v[32:47], v[80:83], v[92:95], v[32:47]
    ds_read_b128 v[72:75], v11 offset:144
    ds_read_b128 v[76:79], v11 offset:656
    v_mfma_f32_32x32x16_bf16 v[32:47], v[84:87], v[88:91], v[32:47]
    ds_read_b64 v[68:69], v10 offset:576
    ds_read_b64 v[70:71], v10 offset:584
    s_waitcnt lgkmcnt(6)
    v_mfma_f32_32x32x16_bf16 v[16:31], v[48:51], v[56:59], v[16:31]
    ds_read_b64 v[80:81], v10 offset:2592
    ds_read_b64 v[82:83], v10 offset:2600
    v_mfma_f32_32x32x16_bf16 v[32:47], v[48:51], v[60:63], v[32:47]
    ds_read_b128 v[88:91], v11 offset:3264
    ds_read_b128 v[92:95], v11 offset:3776
    v_mfma_f32_32x32x16_bf16 v[32:47], v[52:55], v[56:59], v[32:47]
    ds_read_b64 v[84:85], v10 offset:544
    ds_read_b64 v[86:87], v10 offset:552
    s_waitcnt lgkmcnt(6)
    v_mfma_f32_32x32x16_bf16 v[16:31], v[64:67], v[72:75], v[16:31]
    ds_read_b64 v[48:49], v10 offset:2560
    ds_read_b64 v[50:51], v10 offset:2568
    v_mfma_f32_32x32x16_bf16 v[32:47], v[64:67], v[76:79], v[32:47]
    ds_read_b128 v[56:59], v11 offset:128
    ds_read_b128 v[60:63], v11 offset:640
    v_mfma_f32_32x32x16_bf16 v[32:47], v[68:71], v[72:75], v[32:47]
    ds_read_b64 v[52:53], v10 offset:512
    ds_read_b64 v[54:55], v10 offset:520
    s_waitcnt lgkmcnt(6)
    v_mfma_f32_32x32x16_bf16 v[16:31], v[80:83], v[88:91], v[16:31]
    ds_read_b64 v[64:65], v10 offset:2528
    ds_read_b64 v[66:67], v10 offset:2536
    v_mfma_f32_32x32x16_bf16 v[32:47], v[80:83], v[92:95], v[32:47]
    ds_read_b128 v[72:75], v11 offset:3248
    ds_read_b128 v[76:79], v11 offset:3760
    v_mfma_f32_32x32x16_bf16 v[32:47], v[84:87], v[88:91], v[32:47]
    ds_read_b64 v[68:69], v10 offset:480
    ds_read_b64 v[70:71], v10 offset:488
    s_waitcnt lgkmcnt(6)
    v_mfma_f32_32x32x16_bf16 v[16:31], v[48:51], v[56:59], v[16:31]
    ds_read_b64 v[80:81], v10 offset:2496
    ds_read_b64 v[82:83], v10 offset:2504
    v_mfma_f32_32x32x16_bf16 v[32:47], v[48:51], v[60:63], v[32:47]
    ds_read_b128 v[88:91], v11 offset:112
    ds_read_b128 v[92:95], v11 offset:624
    v_mfma_f32_32x32x16_bf16 v[32:47], v[52:55], v[56:59], v[32:47]
    ds_read_b64 v[84:85], v10 offset:448
    ds_read_b64 v[86:87], v10 offset:456
    s_waitcnt lgkmcnt(6)
    v_mfma_f32_32x32x16_bf16 v[16:31], v[64:67], v[72:75], v[16:31]
    ds_read_b64 v[48:49], v10 offset:2464
    ds_read_b64 v[50:51], v10 offset:2472
    v_mfma_f32_32x32x16_bf16 v[32:47], v[64:67], v[76:79], v[32:47]
    ds_read_b128 v[56:59], v11 offset:3232
    ds_read_b128 v[60:63], v11 offset:3744
    v_mfma_f32_32x32x16_bf16 v[32:47], v[68:71], v[72:75], v[32:47]
    ds_read_b64 v[52:53], v10 offset:416
    ds_read_b64 v[54:55], v10 offset:424
    s_waitcnt lgkmcnt(6)
    v_mfma_f32_32x32x16_bf16 v[16:31], v[80:83], v[88:91], v[16:31]
    ds_read_b64 v[64:65], v10 offset:2432
    ds_read_b64 v[66:67], v10 offset:2440
    v_mfma_f32_32x32x16_bf16 v[32:47], v[80:83], v[92:95], v[32:47]
    ds_read_b128 v[72:75], v11 offset:96
    ds_read_b128 v[76:79], v11 offset:608
    v_mfma_f32_32x32x16_bf16 v[32:47], v[84:87], v[88:91], v[32:47]
    ds_read_b64 v[68:69], v10 offset:384
    ds_read_b64 v[70:71], v10 offset:392
    s_waitcnt lgkmcnt(6)
    v_mfma_f32_32x32x16_bf16 v[16:31], v[48:51], v[56:59], v[16:31]
    ds_read_b64 v[80:81], v10 offset:2400
    ds_read_b64 v[82:83], v10 offset:2408
    v_mfma_f32_32x32x16_bf16 v[32:47], v[48:51], v[60:63], v[32:47]
    ds_read_b128 v[88:91], v11 offset:3216
    ds_read_b128 v[92:95], v11 offset:3728
    v_mfma_f32_32x32x16_bf16 v[32:47], v[52:55], v[56:59], v[32:47]
    ds_read_b64 v[84:85], v10 offset:352
    ds_read_b64 v[86:87], v10 offset:360
    s_waitcnt lgkmcnt(6)
    v_mfma_f32_32x32x16_bf16 v[16:31], v[64:67], v[72:75], v[16:31]
    ds_read_b64 v[48:49], v10 offset:2368
    ds_read_b64 v[50:51], v10 offset:2376
    v_mfma_f32_32x32x16_bf16 v[32:47], v[64:67], v[76:79], v[32:47]
    ds_read_b128 v[56:59], v11 offset:80
    ds_read_b128 v[60:63], v11 offset:592
    v_mfma_f32_32x32x16_bf16 v[32:47], v[68:71], v[72:75], v[32:47]
    ds_read_b64 v[52:53], v10 offset:320
    ds_read_b64 v[54:55], v10 offset:328
    s_waitcnt lgkmcnt(6)
    v_mfma_f32_32x32x16_bf16 v[16:31], v[80:83], v[88:91], v[16:31]
    ds_read_b64 v[64:65], v10 offset:2336
    ds_read_b64 v[66:67], v10 offset:2344
    v_mfma_f32_32x32x16_bf16 v[32:47], v[80:83], v[92:95], v[32:47]
    ds_read_b128 v[72:75], v11 offset:3200
    ds_read_b128 v[76:79], v11 offset:3712
    v_mfma_f32_32x32x16_bf16 v[32:47], v[84:87], v[88:91], v[32:47]
    ds_read_b64 v[68:69], v10 offset:288
    ds_read_b64 v[70:71], v10 offset:296
    s_waitcnt lgkmcnt(6)
    v_mfma_f32_32x32x16_bf16 v[16:31], v[48:51], v[56:59], v[16:31]
    ds_read_b64 v[80:81], v10 offset:2304
    ds_read_b64 v[82:83], v10 offset:2312
    v_mfma_f32_32x32x16_bf16 v[32:47], v[48:51], v[60:63], v[32:47]
    ds_read_b128 v[88:91], v11 offset:64
    ds_read_b128 v[92:95], v11 offset:576
    v_mfma_f32_32x32x16_bf16 v[32:47], v[52:55], v[56:59], v[32:47]
    ds_read_b64 v[84:85], v10 offset:256
    ds_read_b64 v[86:87], v10 offset:264
    s_waitcnt lgkmcnt(6)
    v_mfma_f32_32x32x16_bf16 v[16:31], v[64:67], v[72:75], v[16:31]
    ds_read_b64 v[48:49], v10 offset:2272
    ds_read_b64 v[50:51], v10 offset:2280
    v_mfma_f32_32x32x16_bf16 v[32:47], v[64:67], v[76:79], v[32:47]
    ds_read_b128 v[56:59], v11 offset:3184
    ds_read_b128 v[60:63], v11 offset:3696
    v_mfma_f32_32x32x16_bf16 v[32:47], v[68:71], v[72:75], v[32:47]
    ds_read_b64 v[52:53], v10 offset:224
    ds_read_b64 v[54:55], v10 offset:232
    s_waitcnt lgkmcnt(6)
    v_mfma_f32_32x32x16_bf16 v[16:31], v[80:83], v[88:91], v[16:31]
    ds_read_b64 v[64:65], v10 offset:2240
    ds_read_b64 v[66:67], v10 offset:2248
    v_mfma_f32_32x32x16_bf16 v[32:47], v[80:83], v[92:95], v[32:47]
    ds_read_b128 v[72:75], v11 offset:48
    ds_read_b128 v[76:79], v11 offset:560
    v_mfma_f32_32x32x16_bf16 v[32:47], v[84:87], v[88:91], v[32:47]
    ds_read_b64 v[68:69], v10 offset:192
    ds_read_b64 v[70:71], v10 offset:200
    s_waitcnt lgkmcnt(6)
    v_mfma_f32_32x32x16_bf16 v[16:31], v[48:51], v[56:59], v[16:31]
    ds_read_b64 v[80:81], v10 offset:2208
    ds_read_b64 v[82:83], v10 offset:2216
    v_mfma_f32_32x32x16_bf16 v[32:47], v[48:51], v[60:63], v[32:47]
    ds_read_b128 v[88:91], v11 offset:3168
    ds_read_b128 v[92:95], v11 offset:3680
    v_mfma_f32_32x32x16_bf16 v[32:47], v[52:55], v[56:59], v[32:47]
    ds_read_b64 v[84:85], v10 offset:160
    ds_read_b64 v[86:87], v10 offset:168
    s_waitcnt lgkmcnt(6)
    v_mfma_f32_32x32x16_bf16 v[16:31], v[64:67], v[72:75], v[16:31]
    ds_read_b64 v[48:49], v10 offset:2176
    ds_read_b64 v[50:51], v10 offset:2184
    v_mfma_f32_32x32x16_bf16 v[32:47], v[64:67], v[76:79], v[32:47]
    ds_read_b128 v[56:59], v11 offset:32
    ds_read_b128 v[60:63], v11 offset:544
    v_mfma_f32_32x32x16_bf16 v[32:47], v[68:71], v[72:75], v[32:47]
    ds_read_b64 v[52:53], v10 offset:128
    ds_read_b64 v[54:55], v10 offset:136
    s_waitcnt lgkmcnt(6)
    v_mfma_f32_32x32x16_bf16 v[16:31], v[80:83], v[88:91], v[16:31]
    ds_read_b64 v[64:65], v10 offset:2144
    ds_read_b64 v[66:67], v10 offset:2152
    v_mfma_f32_32x32x16_bf16 v[32:47], v[80:83], v[92:95], v[32:47]
    ds_read_b128 v[72:75], v11 offset:3152
    ds_read_b128 v[76:79], v11 offset:3664
    v_mfma_f32_32x32x16_bf16 v[32:47], v[84:87], v[88:91], v[32:47]
    ds_read_b64 v[68:69], v10 offset:96
    ds_read_b64 v[70:71], v10 offset:104
    s_waitcnt lgkmcnt(6)
    v_mfma_f32_32x32x16_bf16 v[16:31], v[48:51], v[56:59], v[16:31]
    ds_read_b64 v[80:81], v10 offset:2112
    ds_read_b64 v[82:83], v10 offset:2120
    v_mfma_f32_32x32x16_bf16 v[32:47], v[48:51], v[60:63], v[32:47]
    ds_read_b128 v[88:91], v11 offset:16
    ds_read_b128 v[92:95], v11 offset:528
    v_mfma_f32_32x32x16_bf16 v[32:47], v[52:55], v[56:59], v[32:47]
    ds_read_b64 v[84:85], v10 offset:64
    ds_read_b64 v[86:87], v10 offset:72
    s_waitcnt lgkmcnt(6)
    v_mfma_f32_32x32x16_bf16 v[16:31], v[64:67], v[72:75], v[16:31]
    ds_read_b64 v[48:49], v10 offset:2080
    ds_read_b64 v[50:51], v10 offset:2088
    v_mfma_f32_32x32x16_bf16 v[32:47], v[64:67], v[76:79], v[32:47]
    ds_read_b128 v[56:59], v11 offset:3136
    ds_read_b128 v[60:63], v11 offset:3648
    v_mfma_f32_32x32x16_bf16 v[32:47], v[68:71], v[72:75], v[32:47]
    ds_read_b64 v[52:53], v10 offset:32
    ds_read_b64 v[54:55], v10 offset:40
    s_waitcnt lgkmcnt(6)
    v_mfma_f32_32x32x16_bf16 v[16:31], v[80:83], v[88:91], v[16:31]
    ds_read_b64 v[64:65], v10 offset:2048
    ds_read_b64 v[66:67], v10 offset:2056
    v_mfma_f32_32x32x16_bf16 v[32:47], v[80:83], v[92:95], v[32:47]
    ds_read_b128 v[72:75], v11 offset:0
    ds_read_b128 v[76:79], v11 offset:512
    v_mfma_f32_32x32x16_bf16 v[32:47], v[84:87], v[88:91], v[32:47]
    ds_read_b64 v[68:69], v10 offset:0
    ds_read_b64 v[70:71], v10 offset:8
    s_waitcnt lgkmcnt(6)
    v_mfma_f32_32x32x16_bf16 v[16:31], v[48:51], v[56:59], v[16:31]
    v_mfma_f32_32x32x16_bf16 v[32:47], v[48:51], v[60:63], v[32:47]
    v_mfma_f32_32x32x16_bf16 v[32:47], v[52:55], v[56:59], v[32:47]
    s_waitcnt lgkmcnt(0)
    v_mfma_f32_32x32x16_bf16 v[16:31], v[64:67], v[72:75], v[16:31]
    v_mfma_f32_32x32x16_bf16 v[32:47], v[64:67], v[76:79], v[32:47]
    v_mfma_f32_32x32x16_bf16 v[32:47], v[68:71], v[72:75], v[32:47]
    v_mul_u32_u24 v4, 144, v2
    v_lshlrev_b32 v5, 4, v3
    s_mul_i32 s30, s3, 9216
    s_add_u32 s30, s30, 98304
    v_add3_u32 v4, v4, v5, s30
    s_nop 4
    ds_write_b128 v4, v[16:19] offset:0
    ds_write_b128 v4, v[20:23] offset:32
    ds_write_b128 v4, v[24:27] offset:64
    ds_write_b128 v4, v[28:31] offset:96
    ds_write_b128 v4, v[32:35] offset:4608
    ds_write_b128 v4, v[36:39] offset:4640
    ds_write_b128 v4, v[40:43] offset:4672
    ds_write_b128 v4, v[44:47] offset:4704
    v_mov_b32 v7, 1
    v_mov_b32 v8, 156444
    s_waitcnt lgkmcnt(0)
    s_mov_b64 exec, 1
    ds_add_u32 v8, v7
    s_mov_b64 exec, -1
    v_mov_b32 v8, 156444
    s_mov_b32 s99, 800000
L_evs_74:
    ds_read_b32 v9, v8
    s_waitcnt lgkmcnt(0)
    v_readfirstlane_b32 s79, v9
    s_cmp_ge_u32 s79, 4
    s_cbranch_scc1 L_evk_75
    s_sub_u32 s99, s99, 1
    s_cmp_eq_u32 s99, 0
    s_cbranch_scc1 L_evk_75
    s_nop 0
    s_branch L_evs_74
L_evk_75:
    v_and_b32 v2, 255, v0
    v_lshrrev_b32 v3, 2, v2
    v_and_b32 v4, 3, v2
    v_mul_u32_u24 v5, 144, v3
    v_lshlrev_b32 v6, 5, v4
    v_add_u32 v5, v5, v6
    v_add_u32 v5, 98304, v5
    v_mul_u32_u24 v6, 1568, v4
    v_lshlrev_b32 v7, 4, v3
    v_add_u32 v6, v6, v7
    v_add_u32 v6, 135680, v6
    v_lshlrev_b32 v7, 4, v2
    v_add_u32 v8, 147712, v7
    ds_read_b128 v[80:83], v5 offset:0
    ds_read_b128 v[84:87], v5 offset:16
    ds_read_b128 v[88:91], v5 offset:9216
    ds_read_b128 v[92:95], v5 offset:9232
    ds_read_b128 v[96:99], v6 offset:0
    ds_read_b128 v[100:103], v8 offset:0
    ds_read_b128 v[104:107], v5 offset:18432
    ds_read_b128 v[108:111], v5 offset:18448
    ds_read_b128 v[112:115], v5 offset:27648
    ds_read_b128 v[116:119], v5 offset:27664
    ds_read_b128 v[120:123], v6 offset:6272
    ds_read_b128 v[124:127], v8 offset:4096
    v_mov_b32 v9, 156480
    ds_read_b64 v[132:133], v9
    s_waitcnt vmcnt(0)
    v_lshlrev_b32 v138, 16, v136
    v_and_b32 v139, 0xffff0000, v136
    s_waitcnt lgkmcnt(0)
    v_add_f32 v80, v80, v88
    v_add_f32 v81, v81, v89
    v_lshlrev_b32 v140, 16, v96
    v_and_b32 v141, 0xffff0000, v96
    v_lshlrev_b32 v142, 16, v100
    v_and_b32 v143, 0xffff0000, v100
    v_fmac_f32 v80, v140, v138
    v_fmac_f32 v81, v141, v138
    v_fma_f32 v80, v80, v132, v142
    v_fma_f32 v81, v81, v132, v143
    v_cvt_pk_bf16_f32 v144, v80, v81
    v_add_f32 v82, v82, v90
    v_add_f32 v83, v83, v91
    v_lshlrev_b32 v140, 16, v97
    v_and_b32 v141, 0xffff0000, v97
    v_lshlrev_b32 v142, 16, v101
    v_and_b32 v143, 0xffff0000, v101
    v_fmac_f32 v82, v140, v138
    v_fmac_f32 v83, v141, v138
    v_fma_f32 v82, v82, v132, v142
    v_fma_f32 v83, v83, v132, v143
    v_cvt_pk_bf16_f32 v145, v82, v83
    v_add_f32 v84, v84, v92
    v_add_f32 v85, v85, v93
    v_lshlrev_b32 v140, 16, v98
    v_and_b32 v141, 0xffff0000, v98
    v_lshlrev_b32 v142, 16, v102
    v_and_b32 v143, 0xffff0000, v102
    v_fmac_f32 v84, v140, v138
    v_fmac_f32 v85, v141, v138
    v_fma_f32 v84, v84, v132, v142
    v_fma_f32 v85, v85, v132, v143
    v_cvt_pk_bf16_f32 v146, v84, v85
    v_add_f32 v86, v86, v94
    v_add_f32 v87, v87, v95
    v_lshlrev_b32 v140, 16, v99
    v_and_b32 v141, 0xffff0000, v99
    v_lshlrev_b32 v142, 16, v103
    v_and_b32 v143, 0xffff0000, v103
    v_fmac_f32 v86, v140, v138
    v_fmac_f32 v87, v141, v138
    v_fma_f32 v86, v86, v132, v142
    v_fma_f32 v87, v87, v132, v143
    v_cvt_pk_bf16_f32 v147, v86, v87
    s_lshl_b32 s30, s5, 13
    s_add_u32 s30, s30, 9437184
    buffer_store_dwordx4 v[144:147], v7, s[8:11], s30 offen sc1
    s_nop 0
    v_add_f32 v104, v104, v112
    v_add_f32 v105, v105, v113
    v_lshlrev_b32 v140, 16, v120
    v_and_b32 v141, 0xffff0000, v120
    v_lshlrev_b32 v142, 16, v124
    v_and_b32 v143, 0xffff0000, v124
    v_fmac_f32 v104, v140, v139
    v_fmac_f32 v105, v141, v139
    v_fma_f32 v104, v104, v133, v142
    v_fma_f32 v105, v105, v133, v143
    v_cvt_pk_bf16_f32 v148, v104, v105
    v_add_f32 v106, v106, v114
    v_add_f32 v107, v107, v115
    v_lshlrev_b32 v140, 16, v121
    v_and_b32 v141, 0xffff0000, v121
    v_lshlrev_b32 v142, 16, v125
    v_and_b32 v143, 0xffff0000, v125
    v_fmac_f32 v106, v140, v139
    v_fmac_f32 v107, v141, v139
    v_fma_f32 v106, v106, v133, v142
    v_fma_f32 v107, v107, v133, v143
    v_cvt_pk_bf16_f32 v149, v106, v107
    v_add_f32 v108, v108, v116
    v_add_f32 v109, v109, v117
    v_lshlrev_b32 v140, 16, v122
    v_and_b32 v141, 0xffff0000, v122
    v_lshlrev_b32 v142, 16, v126
    v_and_b32 v143, 0xffff0000, v126
    v_fmac_f32 v108, v140, v139
    v_fmac_f32 v109, v141, v139
    v_fma_f32 v108, v108, v133, v142
    v_fma_f32 v109, v109, v133, v143
    v_cvt_pk_bf16_f32 v150, v108, v109
    v_add_f32 v110, v110, v118
    v_add_f32 v111, v111, v119
    v_lshlrev_b32 v140, 16, v123
    v_and_b32 v141, 0xffff0000, v123
    v_lshlrev_b32 v142, 16, v127
    v_and_b32 v143, 0xffff0000, v127
    v_fmac_f32 v110, v140, v139
    v_fmac_f32 v111, v141, v139
    v_fma_f32 v110, v110, v133, v142
    v_fma_f32 v111, v111, v133, v143
    v_cvt_pk_bf16_f32 v151, v110, v111
    s_lshl_b32 s30, s5, 13
    s_add_u32 s30, s30, 9441280
    buffer_store_dwordx4 v[148:151], v7, s[8:11], s30 offen sc1
    v_mov_b32 v7, 1
    v_mov_b32 v8, 156468
    s_waitcnt lgkmcnt(0)
    s_mov_b64 exec, 1
    ds_add_u32 v8, v7
    s_mov_b64 exec, -1
    v_mov_b32 v8, 156440
    ds_read_b32 v9, v8
    s_waitcnt lgkmcnt(0)
    v_readfirstlane_b32 s93, v9
    s_cmp_eq_u32 s93, 0
    s_cbranch_scc1 L_nosh_76
    s_lshr_b32 s74, s7, 2
    s_and_b32 s75, s3, 1
    s_lshr_b32 s76, s3, 1
    s_lshl_b32 s74, s74, 1
    s_add_u32 s74, s74, s75
    s_mul_i32 s74, s74, 86
    s_mul_i32 s76, s76, 43
    s_add_u32 s74, s74, s76
    s_add_u32 s74, s74, 35
    s_lshl_b32 s74, s74, 10
    s_add_u32 s74, s74, 7340032
    v_lshlrev_b32 v252, 4, v1
    buffer_load_dwordx4 v[220:223], v252, s[8:11], s74 offen offset:0
    buffer_load_dwordx4 v[224:227], v252, s[8:11], s74 offen offset:1024
    buffer_load_dwordx4 v[228:231], v252, s[8:11], s74 offen offset:2048
    buffer_load_dwordx4 v[232:235], v252, s[8:11], s74 offen offset:3072
    s_add_u32 s74, s74, 4096
    buffer_load_dwordx4 v[236:239], v252, s[8:11], s74 offen offset:0
    buffer_load_dwordx4 v[240:243], v252, s[8:11], s74 offen offset:1024
    buffer_load_dwordx4 v[244:247], v252, s[8:11], s74 offen offset:2048
    buffer_load_dwordx4 v[248:251], v252, s[8:11], s74 offen offset:3072
    s_waitcnt vmcnt(8)
    s_branch L_sh2_77
L_nosh_76:
    s_waitcnt vmcnt(0)
L_sh2_77:
    v_mov_b32 v7, 1
    v_mov_b32 v8, 156432
    s_waitcnt lgkmcnt(0)
    s_mov_b64 exec, 1
    ds_add_rtn_u32 v9, v8, v7
    s_mov_b64 exec, -1
    s_waitcnt lgkmcnt(0)
    v_readfirstlane_b32 s30, v9
    s_cmp_eq_u32 s30, 3
    s_cbranch_scc0 L_nof2_78
    s_lshl_b32 s30, s2, 4
    s_add_u32 s30, s30, 4096
    v_mov_b32 v2, s4
    v_mov_b32 v3, 0
    s_mov_b64 exec, 1
    buffer_store_dword v2, v3, s[8:11], s30 offen sc1
    s_mov_b64 exec, -1
L_nof2_78:
    s_and_b32 s28, s7, 3
    s_and_b32 s29, s6, 3
    s_lshl_b32 s29, s29, 2
    s_add_u32 s28, s28, s29
    s_lshr_b32 s29, s7, 2
    s_lshr_b32 s79, s6, 2
    s_lshl_b32 s79, s79, 3
    s_add_u32 s29, s29, s79
    v_lshrrev_b32 v2, 5, v1
    v_bfe_u32 v3, v1, 2, 2
    v_bfe_u32 v4, v1, 4, 1
    v_and_b32 v5, 3, v1
    v_lshlrev_b32 v6, 3, v2
    v_add_u32 v6, v6, v3
    v_lshlrev_b32 v7, 5, v4
    v_lshlrev_b32 v8, 3, v5
    v_add_u32 v7, v7, v8
    v_mul_u32_u24 v10, 192, v6
    v_add_u32 v10, v10, v7
    v_add_u32 v11, 49152, v10
    v_lshlrev_b32 v12, 8, v6
    v_xor_b32 v8, s3, v3
    v_lshlrev_b32 v8, 6, v8
    v_add3_u32 v12, v12, v8, v7
    v_add_u32 v12, 98304, v12
    v_mov_b32 v76, 156440
    s_mov_b32 s99, 800000
L_evs_81:
    ds_read_b32 v77, v76
    s_waitcnt lgkmcnt(0)
    v_readfirstlane_b32 s79, v77
    s_cmp_ge_u32 s79, 1
    s_cbranch_scc1 L_evk_82
    s_sub_u32 s99, s99, 1
    s_cmp_eq_u32 s99, 0
    s_cbranch_scc1 L_evk_82
    s_sleep 1
    s_branch L_evs_81
L_evk_82:
    v_mov_b32 v76, 156456
    s_mov_b32 s99, 800000
L_evs_83:
    ds_read_b32 v77, v76
    s_waitcnt lgkmcnt(0)
    v_readfirstlane_b32 s79, v77
    s_cmp_ge_u32 s79, 3
    s_cbranch_scc1 L_evk_84
    s_sub_u32 s99, s99, 1
    s_cmp_eq_u32 s99, 0
    s_cbranch_scc1 L_evk_84
    s_sleep 1
    s_branch L_evs_83
L_evk_84:
    s_cmp_lg_u32 s93, 0
    s_cbranch_scc1 L_shdone_85
    s_lshr_b32 s74, s7, 2
    s_and_b32 s75, s3, 1
    s_lshr_b32 s76, s3, 1
    s_lshl_b32 s74, s74, 1
    s_add_u32 s74, s74, s75
    s_mul_i32 s74, s74, 86
    s_mul_i32 s76, s76, 43
    s_add_u32 s74, s74, s76
    s_add_u32 s74, s74, 35
    s_lshl_b32 s74, s74, 10
    s_add_u32 s74, s74, 7340032
    v_lshlrev_b32 v252, 4, v1
    buffer_load_dwordx4 v[220:223], v252, s[8:11], s74 offen offset:0
    buffer_load_dwordx4 v[224:227], v252, s[8:11], s74 offen offset:1024
    buffer_load_dwordx4 v[228:231], v252, s[8:11], s74 offen offset:2048
    buffer_load_dwordx4 v[232:235], v252, s[8:11], s74 offen offset:3072
    s_add_u32 s74, s74, 4096
    buffer_load_dwordx4 v[236:239], v252, s[8:11], s74 offen offset:0
    buffer_load_dwordx4 v[240:243], v252, s[8:11], s74 offen offset:1024
    buffer_load_dwordx4 v[244:247], v252, s[8:11], s74 offen offset:2048
    buffer_load_dwordx4 v[248:251], v252, s[8:11], s74 offen offset:3072
L_shdone_85:
    s_lshr_b32 s74, s7, 2
    s_and_b32 s75, s3, 1
    s_lshr_b32 s76, s3, 1
    s_lshl_b32 s74, s74, 1
    s_add_u32 s74, s74, s75
    s_mul_i32 s74, s74, 86
    s_mul_i32 s76, s76, 43
    s_add_u32 s74, s74, s76
    s_add_u32 s74, s74, 16
    s_lshl_b32 s74, s74, 10
    s_add_u32 s74, s74, 7340032
    v_lshlrev_b32 v252, 4, v1
    buffer_load_dwordx4 v[144:147], v252, s[8:11], s74 offen offset:0
    buffer_load_dwordx4 v[148:151], v252, s[8:11], s74 offen offset:1024
    buffer_load_dwordx4 v[152:155], v252, s[8:11], s74 offen offset:2048
    buffer_load_dwordx4 v[156:159], v252, s[8:11], s74 offen offset:3072
    s_add_u32 s74, s74, 4096
    buffer_load_dwordx4 v[160:163], v252, s[8:11], s74 offen offset:0
    buffer_load_dwordx4 v[164:167], v252, s[8:11], s74 offen offset:1024
    buffer_load_dwordx4 v[168:171], v252, s[8:11], s74 offen offset:2048
    buffer_load_dwordx4 v[172:175], v252, s[8:11], s74 offen offset:3072
    s_add_u32 s74, s74, 4096
    buffer_load_dwordx4 v[176:179], v252, s[8:11], s74 offen offset:0
    buffer_load_dwordx4 v[180:183], v252, s[8:11], s74 offen offset:1024
    buffer_load_dwordx4 v[184:187], v252, s[8:11], s74 offen offset:2048
    buffer_load_dwordx4 v[188:191], v252, s[8:11], s74 offen offset:3072
    s_add_u32 s74, s74, 4096
    buffer_load_dwordx4 v[192:195], v252, s[8:11], s74 offen offset:0
    buffer_load_dwordx4 v[196:199], v252, s[8:11], s74 offen offset:1024
    buffer_load_dwordx4 v[200:203], v252, s[8:11], s74 offen offset:2048
    buffer_load_dwordx4 v[204:207], v252, s[8:11], s74 offen offset:3072
    s_add_u32 s74, s74, 4096
    buffer_load_dwordx4 v[208:211], v252, s[8:11], s74 offen offset:0
    buffer_load_dwordx4 v[212:215], v252, s[8:11], s74 offen offset:1024
    buffer_load_dwordx4 v[216:219], v252, s[8:11], s74 offen offset:2048
    s_waitcnt vmcnt(0)
    v_mov_b32 v76, 1
    v_mov_b32 v77, 156448
    s_waitcnt lgkmcnt(0)
    s_mov_b64 exec, 1
    ds_add_u32 v77, v76
    s_mov_b64 exec, -1
    s_cmp_eq_u32 s29, 15
    s_cbranch_scc1 L_m3idle_79
    v_mov_b32 v13, 0
    v_mov_b32 v14, 0
    s_mov_b32 s31, 0x3f803f80
    s_lshl_b32 s32, s28, 4
    s_lshl_b32 s33, s3, 9
    s_lshl_b32 s34, s32, 11
    s_add_u32 s33, s33, s34
    s_add_u32 s33, s33, 589824
    v_and_b32 v11, 31, v1
    v_lshlrev_b32 v11, 4, v11
    s_add_u32 s34, s29, 0
    s_and_b32 s34, s34, 15
    s_mul_i32 s34, s34, 6144
    v_add_u32 v8, s34, v10
    s_add_u32 s34, s29, 1
    s_and_b32 s34, s34, 15
    s_mul_i32 s34, s34, 6144
    v_add_u32 v9, s34, v10
    s_barrier
    ds_read_b64_tr_b16 v[76:77], v12 offset:0
    ds_read_b64_tr_b16 v[78:79], v12 offset:1024
    ds_read_b64_tr_b16 v[64:65], v8 offset:0
    ds_read_b64_tr_b16 v[66:67], v8 offset:768
    ds_read_b64_tr_b16 v[68:69], v8 offset:64
    ds_read_b64_tr_b16 v[70:71], v8 offset:832
    ds_read_b64_tr_b16 v[72:73], v8 offset:128
    ds_read_b64_tr_b16 v[74:75], v8 offset:896
    ds_read_b64_tr_b16 v[92:93], v12 offset:4096
    ds_read_b64_tr_b16 v[94:95], v12 offset:5120
    ds_read_b64_tr_b16 v[80:81], v8 offset:3072
    ds_read_b64_tr_b16 v[82:83], v8 offset:3840
    ds_read_b64_tr_b16 v[84:85], v8 offset:3136
    ds_read_b64_tr_b16 v[86:87], v8 offset:3904
    s_waitcnt lgkmcnt(12)
    ds_read_b64_tr_b16 v[88:89], v8 offset:3200
    ds_read_b64_tr_b16 v[90:91], v8 offset:3968
    s_waitcnt lgkmcnt(8)
    v_mfma_f32_32x32x16_bf16 v[16:31], v[64:67], v[76:79], 0
    s_barrier
    ds_read_b64_tr_b16 v[108:109], v12 offset:8192
    ds_read_b64_tr_b16 v[110:111], v12 offset:9216
    ds_read_b64_tr_b16 v[96:97], v9 offset:0
    v_mfma_f32_32x32x16_bf16 v[32:47], v[68:71], v[76:79], 0
    ds_read_b64_tr_b16 v[98:99], v9 offset:768
    ds_read_b64_tr_b16 v[100:101], v9 offset:64
    ds_read_b64_tr_b16 v[102:103], v9 offset:832
    v_mfma_f32_32x32x16_bf16 v[48:63], v[72:75], v[76:79], 0
    s_waitcnt lgkmcnt(13)
    ds_read_b64_tr_b16 v[104:105], v9 offset:128
    ds_read_b64_tr_b16 v[106:107], v9 offset:896
    v_dot2c_f32_bf16 v13, s31, v76
    v_dot2c_f32_bf16 v14, v76, v76
    v_dot2c_f32_bf16 v13, s31, v77
    v_dot2c_f32_bf16 v14, v77, v77
    v_dot2c_f32_bf16 v13, s31, v78
    v_dot2c_f32_bf16 v14, v78, v78
    v_dot2c_f32_bf16 v13, s31, v79
    v_dot2c_f32_bf16 v14, v79, v79
    s_waitcnt lgkmcnt(8)
    v_mfma_f32_32x32x16_bf16 v[16:31], v[80:83], v[92:95], v[16:31]
    ds_read_b64_tr_b16 v[76:77], v12 offset:12288
    ds_read_b64_tr_b16 v[78:79], v12 offset:13312
    ds_read_b64_tr_b16 v[64:65], v9 offset:3072
    v_mfma_f32_32x32x16_bf16 v[32:47], v[84:87], v[92:95], v[32:47]
    ds_read_b64_tr_b16 v[66:67], v9 offset:3840
    ds_read_b64_tr_b16 v[68:69], v9 offset:3136
    ds_read_b64_tr_b16 v[70:71], v9 offset:3904
    v_mfma_f32_32x32x16_bf16 v[48:63], v[88:91], v[92:95], v[48:63]
    s_waitcnt lgkmcnt(13)
    ds_read_b64_tr_b16 v[72:73], v9 offset:3200
    ds_read_b64_tr_b16 v[74:75], v9 offset:3968
    s_add_u32 s34, s29, 2
    s_and_b32 s34, s34, 15
    s_mul_i32 s34, s34, 6144
    v_add_u32 v8, s34, v10
    v_dot2c_f32_bf16 v13, s31, v92
    v_dot2c_f32_bf16 v14, v92, v92
    v_dot2c_f32_bf16 v13, s31, v93
    v_dot2c_f32_bf16 v14, v93, v93
    v_dot2c_f32_bf16 v13, s31, v94
    v_dot2c_f32_bf16 v14, v94, v94
    v_dot2c_f32_bf16 v13, s31, v95
    v_dot2c_f32_bf16 v14, v95, v95
    s_mov_b32 s35, s29
    s_nop 0
    v_mov_b32 v2, v13
    v_mov_b32 v3, v14
    s_nop 1
    v_permlane32_swap_b32 v2, v13
    v_permlane32_swap_b32 v3, v14
    s_lshl_b32 s35, s35, 11
    s_add_u32 s35, s35, s33
    v_add_f32 v4, v13, v2
    v_add_f32 v6, v14, v3
    v_mov_b32 v5, s4
    v_mov_b32 v7, s4
    s_mov_b32 exec_hi, 0
    buffer_store_dwordx4 v[4:7], v11, s[8:11], s35 offen sc1
    s_mov_b32 exec_hi, -1
    v_mov_b32 v13, 0
    v_mov_b32 v14, 0
    s_waitcnt lgkmcnt(8)
    v_mfma_f32_32x32x16_bf16 v[16:31], v[96:99], v[108:111], v[16:31]
    s_barrier
    ds_read_b64_tr_b16 v[92:93], v12 offset:16384
    ds_read_b64_tr_b16 v[94:95], v12 offset:17408
    ds_read_b64_tr_b16 v[80:81], v8 offset:0
    v_mfma_f32_32x32x16_bf16 v[32:47], v[100:103], v[108:111], v[32:47]
    ds_read_b64_tr_b16 v[82:83], v8 offset:768
    ds_read_b64_tr_b16 v[84:85], v8 offset:64
    ds_read_b64_tr_b16 v[86:87], v8 offset:832
    v_mfma_f32_32x32x16_bf16 v[48:63], v[104:107], v[108:111], v[48:63]
    s_waitcnt lgkmcnt(13)
    ds_read_b64_tr_b16 v[88:89], v8 offset:128
    ds_read_b64_tr_b16 v[90:91], v8 offset:896
    s_cmp_eq_u32 s29, 14
    s_cbranch_scc0 L_nost14_86
    v_dot2c_f32_bf16 v13, s31, v108
    v_dot2c_f32_bf16 v14, v108, v108
    v_dot2c_f32_bf16 v13, s31, v109
    v_dot2c_f32_bf16 v14, v109, v109
    v_dot2c_f32_bf16 v13, s31, v110
    v_dot2c_f32_bf16 v14, v110, v110
    v_dot2c_f32_bf16 v13, s31, v111
    v_dot2c_f32_bf16 v14, v111, v111
L_nost14_86:
    s_waitcnt lgkmcnt(8)
    v_mfma_f32_32x32x16_bf16 v[16:31], v[64:67], v[76:79], v[16:31]
    ds_read_b64_tr_b16 v[108:109], v12 offset:20480
    ds_read_b64_tr_b16 v[110:111], v12 offset:21504
    ds_read_b64_tr_b16 v[96:97], v8 offset:3072
    v_mfma_f32_32x32x16_bf16 v[32:47], v[68:71], v[76:79], v[32:47]
    ds_read_b64_tr_b16 v[98:99], v8 offset:3840
    ds_read_b64_tr_b16 v[100:101], v8 offset:3136
    ds_read_b64_tr_b16 v[102:103], v8 offset:3904
    v_mfma_f32_32x32x16_bf16 v[48:63], v[72:75], v[76:79], v[48:63]
    s_waitcnt lgkmcnt(13)
    ds_read_b64_tr_b16 v[104:105], v8 offset:3200
    ds_read_b64_tr_b16 v[106:107], v8 offset:3968
    s_add_u32 s34, s29, 3
    s_and_b32 s34, s34, 15
    s_mul_i32 s34, s34, 6144
    v_add_u32 v9, s34, v10
    s_cmp_eq_u32 s29, 14
    s_cbranch_scc0 L_nost14_87
    v_dot2c_f32_bf16 v13, s31, v76
    v_dot2c_f32_bf16 v14, v76, v76
    v_dot2c_f32_bf16 v13, s31, v77
    v_dot2c_f32_bf16 v14, v77, v77
    v_dot2c_f32_bf16 v13, s31, v78
    v_dot2c_f32_bf16 v14, v78, v78
    v_dot2c_f32_bf16 v13, s31, v79
    v_dot2c_f32_bf16 v14, v79, v79
    s_mov_b32 s35, 15
    s_nop 0
    v_mov_b32 v2, v13
    v_mov_b32 v3, v14
    s_nop 1
    v_permlane32_swap_b32 v2, v13
    v_permlane32_swap_b32 v3, v14
    s_lshl_b32 s35, s35, 11
    s_add_u32 s35, s35, s33
    v_add_f32 v4, v13, v2
    v_add_f32 v6, v14, v3
    v_mov_b32 v5, s4
    v_mov_b32 v7, s4
    s_mov_b32 exec_hi, 0
    buffer_store_dwordx4 v[4:7], v11, s[8:11], s35 offen sc1
    s_mov_b32 exec_hi, -1
    v_mov_b32 v13, 0
    v_mov_b32 v14, 0
L_nost14_87:
    s_waitcnt lgkmcnt(8)
    v_mfma_f32_32x32x16_bf16 v[16:31], v[80:83], v[92:95], v[16:31]
    s_barrier
    ds_read_b64_tr_b16 v[76:77], v12 offset:24576
    ds_read_b64_tr_b16 v[78:79], v12 offset:25600
    ds_read_b64_tr_b16 v[64:65], v9 offset:0
    v_mfma_f32_32x32x16_bf16 v[32:47], v[84:87], v[92:95], v[32:47]
    ds_read_b64_tr_b16 v[66:67], v9 offset:768
    ds_read_b64_tr_b16 v[68:69], v9 offset:64
    ds_read_b64_tr_b16 v[70:71], v9 offset:832
    v_mfma_f32_32x32x16_bf16 v[48:63], v[88:91], v[92:95], v[48:63]
    s_waitcnt lgkmcnt(13)
    ds_read_b64_tr_b16 v[72:73], v9 offset:128
    ds_read_b64_tr_b16 v[74:75], v9 offset:896
    s_waitcnt lgkmcnt(8)
    v_mfma_f32_32x32x16_bf16 v[16:31], v[96:99], v[108:111], v[16:31]
    ds_read_b64_tr_b16 v[92:93], v12 offset:28672
    ds_read_b64_tr_b16 v[94:95], v12 offset:29696
    ds_read_b64_tr_b16 v[80:81], v9 offset:3072
    v_mfma_f32_32x32x16_bf16 v[32:47], v[100:103], v[108:111], v[32:47]
    ds_read_b64_tr_b16 v[82:83], v9 offset:3840
    ds_read_b64_tr_b16 v[84:85], v9 offset:3136
    ds_read_b64_tr_b16 v[86:87], v9 offset:3904
    v_mfma_f32_32x32x16_bf16 v[48:63], v[104:107], v[108:111], v[48:63]
    s_waitcnt lgkmcnt(13)
    ds_read_b64_tr_b16 v[88:89], v9 offset:3200
    ds_read_b64_tr_b16 v[90:91], v9 offset:3968
    s_add_u32 s34, s29, 4
    s_and_b32 s34, s34, 15
    s_mul_i32 s34, s34, 6144
    v_add_u32 v8, s34, v10
    s_waitcnt lgkmcnt(8)
    v_mfma_f32_32x32x16_bf16 v[16:31], v[64:67], v[76:79], v[16:31]
    s_barrier
    ds_read_b64_tr_b16 v[108:109], v12 offset:32768
    ds_read_b64_tr_b16 v[110:111], v12 offset:33792
    ds_read_b64_tr_b16 v[96:97], v8 offset:0
    v_mfma_f32_32x32x16_bf16 v[32:47], v[68:71], v[76:79], v[32:47]
    ds_read_b64_tr_b16 v[98:99], v8 offset:768
    ds_read_b64_tr_b16 v[100:101], v8 offset:64
    ds_read_b64_tr_b16 v[102:103], v8 offset:832
    v_mfma_f32_32x32x16_bf16 v[48:63], v[72:75], v[76:79], v[48:63]
    s_waitcnt lgkmcnt(13)
    ds_read_b64_tr_b16 v[104:105], v8 offset:128
    ds_read_b64_tr_b16 v[106:107], v8 offset:896
    s_waitcnt lgkmcnt(8)
    v_mfma_f32_32x32x16_bf16 v[16:31], v[80:83], v[92:95], v[16:31]
    ds_read_b64_tr_b16 v[76:77], v12 offset:36864
    ds_read_b64_tr_b16 v[78:79], v12 offset:37888
    ds_read_b64_tr_b16 v[64:65], v8 offset:3072
    v_mfma_f32_32x32x16_bf16 v[32:47], v[84:87], v[92:95], v[32:47]
    ds_read_b64_tr_b16 v[66:67], v8 offset:3840
    ds_read_b64_tr_b16 v[68:69], v8 offset:3136
    ds_read_b64_tr_b16 v[70:71], v8 offset:3904
    v_mfma_f32_32x32x16_bf16 v[48:63], v[88:91], v[92:95], v[48:63]
    s_waitcnt lgkmcnt(13)
    ds_read_b64_tr_b16 v[72:73], v8 offset:3200
    ds_read_b64_tr_b16 v[74:75], v8 offset:3968
    s_add_u32 s34, s29, 5
    s_and_b32 s34, s34, 15
    s_mul_i32 s34, s34, 6144
    v_add_u32 v9, s34, v10
    s_waitcnt lgkmcnt(8)
    v_mfma_f32_32x32x16_bf16 v[16:31], v[96:99], v[108:111], v[16:31]
    s_barrier
    ds_read_b64_tr_b16 v[92:93], v12 offset:40960
    ds_read_b64_tr_b16 v[94:95], v12 offset:41984
    ds_read_b64_tr_b16 v[80:81], v9 offset:0
    v_mfma_f32_32x32x16_bf16 v[32:47], v[100:103], v[108:111], v[32:47]
    ds_read_b64_tr_b16 v[82:83], v9 offset:768
    ds_read_b64_tr_b16 v[84:85], v9 offset:64
    ds_read_b64_tr_b16 v[86:87], v9 offset:832
    v_mfma_f32_32x32x16_bf16 v[48:63], v[104:107], v[108:111], v[48:63]
    s_waitcnt lgkmcnt(13)
    ds_read_b64_tr_b16 v[88:89], v9 offset:128
    ds_read_b64_tr_b16 v[90:91], v9 offset:896
    s_waitcnt lgkmcnt(8)
    v_mfma_f32_32x32x16_bf16 v[16:31], v[64:67], v[76:79], v[16:31]
    ds_read_b64_tr_b16 v[108:109], v12 offset:45056
    ds_read_b64_tr_b16 v[110:111], v12 offset:46080
    ds_read_b64_tr_b16 v[96:97], v9 offset:3072
    v_mfma_f32_32x32x16_bf16 v[32:47], v[68:71], v[76:79], v[32:47]
    ds_read_b64_tr_b16 v[98:99], v9 offset:3840
    ds_read_b64_tr_b16 v[100:101], v9 offset:3136
    ds_read_b64_tr_b16 v[102:103], v9 offset:3904
    v_mfma_f32_32x32x16_bf16 v[48:63], v[72:75], v[76:79], v[48:63]
    s_waitcnt lgkmcnt(13)
    ds_read_b64_tr_b16 v[104:105], v9 offset:3200
    ds_read_b64_tr_b16 v[106:107], v9 offset:3968
    s_add_u32 s34, s29, 6
    s_and_b32 s34, s34, 15
    s_mul_i32 s34, s34, 6144
    v_add_u32 v8, s34, v10
    s_waitcnt lgkmcnt(8)
    v_mfma_f32_32x32x16_bf16 v[16:31], v[80:83], v[92:95], v[16:31]
    s_barrier
    ds_read_b64_tr_b16 v[76:77], v12 offset:0
    ds_read_b64_tr_b16 v[78:79], v12 offset:1024
    ds_read_b64_tr_b16 v[64:65], v8 offset:0
    v_mfma_f32_32x32x16_bf16 v[32:47], v[84:87], v[92:95], v[32:47]
    ds_read_b64_tr_b16 v[66:67], v8 offset:768
    ds_read_b64_tr_b16 v[68:69], v8 offset:64
    ds_read_b64_tr_b16 v[70:71], v8 offset:832
    v_mfma_f32_32x32x16_bf16 v[48:63], v[88:91], v[92:95], v[48:63]
    s_waitcnt lgkmcnt(13)
    ds_read_b64_tr_b16 v[72:73], v8 offset:128
    ds_read_b64_tr_b16 v[74:75], v8 offset:896
    s_waitcnt lgkmcnt(8)
    v_mfma_f32_32x32x16_bf16 v[16:31], v[96:99], v[108:111], v[16:31]
    ds_read_b64_tr_b16 v[92:93], v12 offset:4096
    ds_read_b64_tr_b16 v[94:95], v12 offset:5120
    ds_read_b64_tr_b16 v[80:81], v8 offset:3072
    v_mfma_f32_32x32x16_bf16 v[32:47], v[100:103], v[108:111], v[32:47]
    ds_read_b64_tr_b16 v[82:83], v8 offset:3840
    ds_read_b64_tr_b16 v[84:85], v8 offset:3136
    ds_read_b64_tr_b16 v[86:87], v8 offset:3904
    v_mfma_f32_32x32x16_bf16 v[48:63], v[104:107], v[108:111], v[48:63]
    s_waitcnt lgkmcnt(13)
    ds_read_b64_tr_b16 v[88:89], v8 offset:3200
    ds_read_b64_tr_b16 v[90:91], v8 offset:3968
    s_add_u32 s34, s29, 7
    s_and_b32 s34, s34, 15
    s_mul_i32 s34, s34, 6144
    v_add_u32 v9, s34, v10
    s_waitcnt lgkmcnt(8)
    v_mfma_f32_32x32x16_bf16 v[16:31], v[64:67], v[76:79], v[16:31]
    s_barrier
    ds_read_b64_tr_b16 v[108:109], v12 offset:8192
    ds_read_b64_tr_b16 v[110:111], v12 offset:9216
    ds_read_b64_tr_b16 v[96:97], v9 offset:0
    v_mfma_f32_32x32x16_bf16 v[32:47], v[68:71], v[76:79], v[32:47]
    ds_read_b64_tr_b16 v[98:99], v9 offset:768
    ds_read_b64_tr_b16 v[100:101], v9 offset:64
    ds_read_b64_tr_b16 v[102:103], v9 offset:832
    v_mfma_f32_32x32x16_bf16 v[48:63], v[72:75], v[76:79], v[48:63]
    s_waitcnt lgkmcnt(13)
    ds_read_b64_tr_b16 v[104:105], v9 offset:128
    ds_read_b64_tr_b16 v[106:107], v9 offset:896
    s_waitcnt lgkmcnt(8)
    v_mfma_f32_32x32x16_bf16 v[16:31], v[80:83], v[92:95], v[16:31]
    ds_read_b64_tr_b16 v[76:77], v12 offset:12288
    ds_read_b64_tr_b16 v[78:79], v12 offset:13312
    ds_read_b64_tr_b16 v[64:65], v9 offset:3072
    v_mfma_f32_32x32x16_bf16 v[32:47], v[84:87], v[92:95], v[32:47]
    ds_read_b64_tr_b16 v[66:67], v9 offset:3840
    ds_read_b64_tr_b16 v[68:69], v9 offset:3136
    ds_read_b64_tr_b16 v[70:71], v9 offset:3904
    v_mfma_f32_32x32x16_bf16 v[48:63], v[88:91], v[92:95], v[48:63]
    s_waitcnt lgkmcnt(13)
    ds_read_b64_tr_b16 v[72:73], v9 offset:3200
    ds_read_b64_tr_b16 v[74:75], v9 offset:3968
    s_add_u32 s34, s29, 8
    s_and_b32 s34, s34, 15
    s_mul_i32 s34, s34, 6144
    v_add_u32 v8, s34, v10
    s_waitcnt lgkmcnt(8)
    v_mfma_f32_32x32x16_bf16 v[16:31], v[96:99], v[108:111], v[16:31]
    s_barrier
    ds_read_b64_tr_b16 v[92:93], v12 offset:16384
    ds_read_b64_tr_b16 v[94:95], v12 offset:17408
    ds_read_b64_tr_b16 v[80:81], v8 offset:0
    v_mfma_f32_32x32x16_bf16 v[32:47], v[100:103], v[108:111], v[32:47]
    ds_read_b64_tr_b16 v[82:83], v8 offset:768
    ds_read_b64_tr_b16 v[84:85], v8 offset:64
    ds_read_b64_tr_b16 v[86:87], v8 offset:832
    v_mfma_f32_32x32x16_bf16 v[48:63], v[104:107], v[108:111], v[48:63]
    s_waitcnt lgkmcnt(13)
    ds_read_b64_tr_b16 v[88:89], v8 offset:128
    ds_read_b64_tr_b16 v[90:91], v8 offset:896
    s_waitcnt lgkmcnt(8)
    v_mfma_f32_32x32x16_bf16 v[16:31], v[64:67], v[76:79], v[16:31]
    ds_read_b64_tr_b16 v[108:109], v12 offset:20480
    ds_read_b64_tr_b16 v[110:111], v12 offset:21504
    ds_read_b64_tr_b16 v[96:97], v8 offset:3072
    v_mfma_f32_32x32x16_bf16 v[32:47], v[68:71], v[76:79], v[32:47]
    ds_read_b64_tr_b16 v[98:99], v8 offset:3840
    ds_read_b64_tr_b16 v[100:101], v8 offset:3136
    ds_read_b64_tr_b16 v[102:103], v8 offset:3904
    v_mfma_f32_32x32x16_bf16 v[48:63], v[72:75], v[76:79], v[48:63]
    s_waitcnt lgkmcnt(13)
    ds_read_b64_tr_b16 v[104:105], v8 offset:3200
    ds_read_b64_tr_b16 v[106:107], v8 offset:3968
    s_add_u32 s34, s29, 9
    s_and_b32 s34, s34, 15
    s_mul_i32 s34, s34, 6144
    v_add_u32 v9, s34, v10
    s_waitcnt lgkmcnt(8)
    v_mfma_f32_32x32x16_bf16 v[16:31], v[80:83], v[92:95], v[16:31]
    s_barrier
    ds_read_b64_tr_b16 v[76:77], v12 offset:24576
    ds_read_b64_tr_b16 v[78:79], v12 offset:25600
    ds_read_b64_tr_b16 v[64:65], v9 offset:0
    v_mfma_f32_32x32x16_bf16 v[32:47], v[84:87], v[92:95], v[32:47]
    ds_read_b64_tr_b16 v[66:67], v9 offset:768
    ds_read_b64_tr_b16 v[68:69], v9 offset:64
    ds_read_b64_tr_b16 v[70:71], v9 offset:832
    v_mfma_f32_32x32x16_bf16 v[48:63], v[88:91], v[92:95], v[48:63]
    s_waitcnt lgkmcnt(13)
    ds_read_b64_tr_b16 v[72:73], v9 offset:128
    ds_read_b64_tr_b16 v[74:75], v9 offset:896
    s_waitcnt lgkmcnt(8)
    v_mfma_f32_32x32x16_bf16 v[16:31], v[96:99], v[108:111], v[16:31]
    ds_read_b64_tr_b16 v[92:93], v12 offset:28672
    ds_read_b64_tr_b16 v[94:95], v12 offset:29696
    ds_read_b64_tr_b16 v[80:81], v9 offset:3072
    v_mfma_f32_32x32x16_bf16 v[32:47], v[100:103], v[108:111], v[32:47]
    ds_read_b64_tr_b16 v[82:83], v9 offset:3840
    ds_read_b64_tr_b16 v[84:85], v9 offset:3136
    ds_read_b64_tr_b16 v[86:87], v9 offset:3904
    v_mfma_f32_32x32x16_bf16 v[48:63], v[104:107], v[108:111], v[48:63]
    s_waitcnt lgkmcnt(13)
    ds_read_b64_tr_b16 v[88:89], v9 offset:3200
    ds_read_b64_tr_b16 v[90:91], v9 offset:3968
    s_add_u32 s34, s29, 10
    s_and_b32 s34, s34, 15
    s_mul_i32 s34, s34, 6144
    v_add_u32 v8, s34, v10
    s_waitcnt lgkmcnt(8)
    v_mfma_f32_32x32x16_bf16 v[16:31], v[64:67], v[76:79], v[16:31]
    s_barrier
    ds_read_b64_tr_b16 v[108:109], v12 offset:32768
    ds_read_b64_tr_b16 v[110:111], v12 offset:33792
    ds_read_b64_tr_b16 v[96:97], v8 offset:0
    v_mfma_f32_32x32x16_bf16 v[32:47], v[68:71], v[76:79], v[32:47]
    ds_read_b64_tr_b16 v[98:99], v8 offset:768
    ds_read_b64_tr_b16 v[100:101], v8 offset:64
    ds_read_b64_tr_b16 v[102:103], v8 offset:832
    v_mfma_f32_32x32x16_bf16 v[48:63], v[72:75], v[76:79], v[48:63]
    s_waitcnt lgkmcnt(13)
    ds_read_b64_tr_b16 v[104:105], v8 offset:128
    ds_read_b64_tr_b16 v[106:107], v8 offset:896
    s_waitcnt lgkmcnt(8)
    v_mfma_f32_32x32x16_bf16 v[16:31], v[80:83], v[92:95], v[16:31]
    ds_read_b64_tr_b16 v[76:77], v12 offset:36864
    ds_read_b64_tr_b16 v[78:79], v12 offset:37888
    ds_read_b64_tr_b16 v[64:65], v8 offset:3072
    v_mfma_f32_32x32x16_bf16 v[32:47], v[84:87], v[92:95], v[32:47]
    ds_read_b64_tr_b16 v[66:67], v8 offset:3840
    ds_read_b64_tr_b16 v[68:69], v8 offset:3136
    ds_read_b64_tr_b16 v[70:71], v8 offset:3904
    v_mfma_f32_32x32x16_bf16 v[48:63], v[88:91], v[92:95], v[48:63]
    s_waitcnt lgkmcnt(13)
    ds_read_b64_tr_b16 v[72:73], v8 offset:3200
    ds_read_b64_tr_b16 v[74:75], v8 offset:3968
    s_add_u32 s34, s29, 11
    s_and_b32 s34, s34, 15
    s_mul_i32 s34, s34, 6144
    v_add_u32 v9, s34, v10
    s_waitcnt lgkmcnt(8)
    v_mfma_f32_32x32x16_bf16 v[16:31], v[96:99], v[108:111], v[16:31]
    s_barrier
    ds_read_b64_tr_b16 v[92:93], v12 offset:40960
    ds_read_b64_tr_b16 v[94:95], v12 offset:41984
    ds_read_b64_tr_b16 v[80:81], v9 offset:0
    v_mfma_f32_32x32x16_bf16 v[32:47], v[100:103], v[108:111], v[32:47]
    ds_read_b64_tr_b16 v[82:83], v9 offset:768
    ds_read_b64_tr_b16 v[84:85], v9 offset:64
    ds_read_b64_tr_b16 v[86:87], v9 offset:832
    v_mfma_f32_32x32x16_bf16 v[48:63], v[104:107], v[108:111], v[48:63]
    s_waitcnt lgkmcnt(13)
    ds_read_b64_tr_b16 v[88:89], v9 offset:128
    ds_read_b64_tr_b16 v[90:91], v9 offset:896
    s_waitcnt lgkmcnt(8)
    v_mfma_f32_32x32x16_bf16 v[16:31], v[64:67], v[76:79], v[16:31]
    ds_read_b64_tr_b16 v[108:109], v12 offset:45056
    ds_read_b64_tr_b16 v[110:111], v12 offset:46080
    ds_read_b64_tr_b16 v[96:97], v9 offset:3072
    v_mfma_f32_32x32x16_bf16 v[32:47], v[68:71], v[76:79], v[32:47]
    ds_read_b64_tr_b16 v[98:99], v9 offset:3840
    ds_read_b64_tr_b16 v[100:101], v9 offset:3136
    ds_read_b64_tr_b16 v[102:103], v9 offset:3904
    v_mfma_f32_32x32x16_bf16 v[48:63], v[72:75], v[76:79], v[48:63]
    s_waitcnt lgkmcnt(13)
    ds_read_b64_tr_b16 v[104:105], v9 offset:3200
    ds_read_b64_tr_b16 v[106:107], v9 offset:3968
    s_add_u32 s34, s29, 12
    s_and_b32 s34, s34, 15
    s_mul_i32 s34, s34, 6144
    v_add_u32 v8, s34, v10
    s_waitcnt lgkmcnt(8)
    v_mfma_f32_32x32x16_bf16 v[16:31], v[80:83], v[92:95], v[16:31]
    s_barrier
    ds_read_b64_tr_b16 v[76:77], v12 offset:0
    ds_read_b64_tr_b16 v[78:79], v12 offset:1024
    ds_read_b64_tr_b16 v[64:65], v8 offset:0
    v_mfma_f32_32x32x16_bf16 v[32:47], v[84:87], v[92:95], v[32:47]
    ds_read_b64_tr_b16 v[66:67], v8 offset:768
    ds_read_b64_tr_b16 v[68:69], v8 offset:64
    ds_read_b64_tr_b16 v[70:71], v8 offset:832
    v_mfma_f32_32x32x16_bf16 v[48:63], v[88:91], v[92:95], v[48:63]
    s_waitcnt lgkmcnt(13)
    ds_read_b64_tr_b16 v[72:73], v8 offset:128
    ds_read_b64_tr_b16 v[74:75], v8 offset:896
    s_waitcnt lgkmcnt(8)
    v_mfma_f32_32x32x16_bf16 v[16:31], v[96:99], v[108:111], v[16:31]
    ds_read_b64_tr_b16 v[92:93], v12 offset:4096
    ds_read_b64_tr_b16 v[94:95], v12 offset:5120
    ds_read_b64_tr_b16 v[80:81], v8 offset:3072
    v_mfma_f32_32x32x16_bf16 v[32:47], v[100:103], v[108:111], v[32:47]
    ds_read_b64_tr_b16 v[82:83], v8 offset:3840
    ds_read_b64_tr_b16 v[84:85], v8 offset:3136
    ds_read_b64_tr_b16 v[86:87], v8 offset:3904
    v_mfma_f32_32x32x16_bf16 v[48:63], v[104:107], v[108:111], v[48:63]
    s_waitcnt lgkmcnt(13)
    ds_read_b64_tr_b16 v[88:89], v8 offset:3200
    ds_read_b64_tr_b16 v[90:91], v8 offset:3968
    s_add_u32 s34, s29, 13
    s_and_b32 s34, s34, 15
    s_mul_i32 s34, s34, 6144
    v_add_u32 v9, s34, v10
    s_waitcnt lgkmcnt(8)
    v_mfma_f32_32x32x16_bf16 v[16:31], v[64:67], v[76:79], v[16:31]
    s_barrier
    ds_read_b64_tr_b16 v[108:109], v12 offset:8192
    ds_read_b64_tr_b16 v[110:111], v12 offset:9216
    ds_read_b64_tr_b16 v[96:97], v9 offset:0
    v_mfma_f32_32x32x16_bf16 v[32:47], v[68:71], v[76:79], v[32:47]
    ds_read_b64_tr_b16 v[98:99], v9 offset:768
    ds_read_b64_tr_b16 v[100:101], v9 offset:64
    ds_read_b64_tr_b16 v[102:103], v9 offset:832
    v_mfma_f32_32x32x16_bf16 v[48:63], v[72:75], v[76:79], v[48:63]
    s_waitcnt lgkmcnt(13)
    ds_read_b64_tr_b16 v[104:105], v9 offset:128
    ds_read_b64_tr_b16 v[106:107], v9 offset:896
    s_waitcnt lgkmcnt(8)
    v_mfma_f32_32x32x16_bf16 v[16:31], v[80:83], v[92:95], v[16:31]
    ds_read_b64_tr_b16 v[76:77], v12 offset:12288
    ds_read_b64_tr_b16 v[78:79], v12 offset:13312
    ds_read_b64_tr_b16 v[64:65], v9 offset:3072
    v_mfma_f32_32x32x16_bf16 v[32:47], v[84:87], v[92:95], v[32:47]
    ds_read_b64_tr_b16 v[66:67], v9 offset:3840
    ds_read_b64_tr_b16 v[68:69], v9 offset:3136
    ds_read_b64_tr_b16 v[70:71], v9 offset:3904
    v_mfma_f32_32x32x16_bf16 v[48:63], v[88:91], v[92:95], v[48:63]
    s_waitcnt lgkmcnt(13)
    ds_read_b64_tr_b16 v[72:73], v9 offset:3200
    ds_read_b64_tr_b16 v[74:75], v9 offset:3968
    s_add_u32 s34, s29, 14
    s_and_b32 s34, s34, 15
    s_mul_i32 s34, s34, 6144
    v_add_u32 v8, s34, v10
    s_waitcnt lgkmcnt(8)
    v_mfma_f32_32x32x16_bf16 v[16:31], v[96:99], v[108:111], v[16:31]
    s_barrier
    ds_read_b64_tr_b16 v[92:93], v12 offset:16384
    ds_read_b64_tr_b16 v[94:95], v12 offset:17408
    ds_read_b64_tr_b16 v[80:81], v8 offset:0
    v_mfma_f32_32x32x16_bf16 v[32:47], v[100:103], v[108:111], v[32:47]
    ds_read_b64_tr_b16 v[82:83], v8 offset:768
    ds_read_b64_tr_b16 v[84:85], v8 offset:64
    ds_read_b64_tr_b16 v[86:87], v8 offset:832
    v_mfma_f32_32x32x16_bf16 v[48:63], v[104:107], v[108:111], v[48:63]
    s_waitcnt lgkmcnt(13)
    ds_read_b64_tr_b16 v[88:89], v8 offset:128
    ds_read_b64_tr_b16 v[90:91], v8 offset:896
    s_waitcnt lgkmcnt(8)
    v_mfma_f32_32x32x16_bf16 v[16:31], v[64:67], v[76:79], v[16:31]
    ds_read_b64_tr_b16 v[108:109], v12 offset:20480
    ds_read_b64_tr_b16 v[110:111], v12 offset:21504
    ds_read_b64_tr_b16 v[96:97], v8 offset:3072
    v_mfma_f32_32x32x16_bf16 v[32:47], v[68:71], v[76:79], v[32:47]
    ds_read_b64_tr_b16 v[98:99], v8 offset:3840
    ds_read_b64_tr_b16 v[100:101], v8 offset:3136
    ds_read_b64_tr_b16 v[102:103], v8 offset:3904
    v_mfma_f32_32x32x16_bf16 v[48:63], v[72:75], v[76:79], v[48:63]
    s_waitcnt lgkmcnt(13)
    ds_read_b64_tr_b16 v[104:105], v8 offset:3200
    ds_read_b64_tr_b16 v[106:107], v8 offset:3968
    s_add_u32 s34, s29, 15
    s_and_b32 s34, s34, 15
    s_mul_i32 s34, s34, 6144
    v_add_u32 v9, s34, v10
    s_waitcnt lgkmcnt(8)
    v_mfma_f32_32x32x16_bf16 v[16:31], v[80:83], v[92:95], v[16:31]
    s_barrier
    ds_read_b64_tr_b16 v[76:77], v12 offset:24576
    ds_read_b64_tr_b16 v[78:79], v12 offset:25600
    ds_read_b64_tr_b16 v[64:65], v9 offset:0
    v_mfma_f32_32x32x16_bf16 v[32:47], v[84:87], v[92:95], v[32:47]
    ds_read_b64_tr_b16 v[66:67], v9 offset:768
    ds_read_b64_tr_b16 v[68:69], v9 offset:64
    ds_read_b64_tr_b16 v[70:71], v9 offset:832
    v_mfma_f32_32x32x16_bf16 v[48:63], v[88:91], v[92:95], v[48:63]
    s_waitcnt lgkmcnt(13)
    ds_read_b64_tr_b16 v[72:73], v9 offset:128
    ds_read_b64_tr_b16 v[74:75], v9 offset:896
    s_waitcnt lgkmcnt(8)
    v_mfma_f32_32x32x16_bf16 v[16:31], v[96:99], v[108:111], v[16:31]
    ds_read_b64_tr_b16 v[92:93], v12 offset:28672
    ds_read_b64_tr_b16 v[94:95], v12 offset:29696
    ds_read_b64_tr_b16 v[80:81], v9 offset:3072
    v_mfma_f32_32x32x16_bf16 v[32:47], v[100:103], v[108:111], v[32:47]
    ds_read_b64_tr_b16 v[82:83], v9 offset:3840
    ds_read_b64_tr_b16 v[84:85], v9 offset:3136
    ds_read_b64_tr_b16 v[86:87], v9 offset:3904
    v_mfma_f32_32x32x16_bf16 v[48:63], v[104:107], v[108:111], v[48:63]
    s_waitcnt lgkmcnt(13)
    ds_read_b64_tr_b16 v[88:89], v9 offset:3200
    ds_read_b64_tr_b16 v[90:91], v9 offset:3968
    s_waitcnt lgkmcnt(8)
    v_mfma_f32_32x32x16_bf16 v[16:31], v[64:67], v[76:79], v[16:31]
    v_mfma_f32_32x32x16_bf16 v[32:47], v[68:71], v[76:79], v[32:47]
    v_mfma_f32_32x32x16_bf16 v[48:63], v[72:75], v[76:79], v[48:63]
    s_waitcnt lgkmcnt(0)
    v_mfma_f32_32x32x16_bf16 v[16:31], v[80:83], v[92:95], v[16:31]
    v_mfma_f32_32x32x16_bf16 v[32:47], v[84:87], v[92:95], v[32:47]
    v_mfma_f32_32x32x16_bf16 v[48:63], v[88:91], v[92:95], v[48:63]
    v_mov_b32 v2, 156472
    s_mov_b32 s99, 800000
L_evs_88:
    ds_read_b32 v3, v2
    s_waitcnt lgkmcnt(0)
    v_readfirstlane_b32 s79, v3
    s_cmp_ge_u32 s79, 4
    s_cbranch_scc1 L_evk_89
    s_sub_u32 s99, s99, 1
    s_cmp_eq_u32 s99, 0
    s_cbranch_scc1 L_evk_89
    s_nop 0
    s_branch L_evs_88
L_evk_89:
    v_and_b32 v2, 31, v1
    v_lshlrev_b32 v2, 3, v2
    s_lshl_b32 s30, s3, 8
    v_add_u32 v2, s30, v2
    v_add_u32 v2, 161792, v2
    ds_read_b64 v[6:7], v2
    s_waitcnt lgkmcnt(0)
    v_lshrrev_b32 v2, 5, v1
    v_lshlrev_b32 v2, 4, v2
    v_add_u32 v2, 161024, v2
    v_lshlrev_b32 v3, 4, v1
    s_lshl_b32 s30, s28, 2
    s_add_u32 s30, s30, s3
    s_mul_i32 s30, s30, 88064
    s_mul_i32 s31, s29, 6144
    s_add_u32 s30, s30, s31
    s_add_u32 s30, s30, 11534336
    ds_read_b128 v[64:67], v2 offset:0
    ds_read_b128 v[68:71], v2 offset:384
    ds_read_b128 v[72:75], v2 offset:32
    ds_read_b128 v[76:79], v2 offset:416
    s_waitcnt lgkmcnt(2)
    v_pk_fma_f32 v[16:17], v[6:7], v[64:65], v[16:17] op_sel_hi:[0,1,1] neg_lo:[1,0,0] neg_hi:[1,0,0]
    v_pk_fma_f32 v[18:19], v[6:7], v[66:67], v[18:19] op_sel_hi:[0,1,1] neg_lo:[1,0,0] neg_hi:[1,0,0]
    v_pk_fma_f32 v[16:17], v[6:7], v[16:17], v[68:69] op_sel:[1,0,0] op_sel_hi:[1,1,1]
    v_pk_fma_f32 v[18:19], v[6:7], v[18:19], v[70:71] op_sel:[1,0,0] op_sel_hi:[1,1,1]
    v_max_f32 v16, 0, v16
    v_max_f32 v17, 0, v17
    v_max_f32 v18, 0, v18
    v_max_f32 v19, 0, v19
    v_pk_mul_f32 v[16:17], v[16:17], v[16:17]
    v_pk_mul_f32 v[18:19], v[18:19], v[18:19]
    v_cvt_pk_bf16_f32 v8, v16, v17
    v_cvt_pk_bf16_f32 v9, v18, v19
    ds_read_b128 v[64:67], v2 offset:64
    ds_read_b128 v[68:71], v2 offset:448
    s_waitcnt lgkmcnt(2)
    v_pk_fma_f32 v[20:21], v[6:7], v[72:73], v[20:21] op_sel_hi:[0,1,1] neg_lo:[1,0,0] neg_hi:[1,0,0]
    v_pk_fma_f32 v[22:23], v[6:7], v[74:75], v[22:23] op_sel_hi:[0,1,1] neg_lo:[1,0,0] neg_hi:[1,0,0]
    v_pk_fma_f32 v[20:21], v[6:7], v[20:21], v[76:77] op_sel:[1,0,0] op_sel_hi:[1,1,1]
    v_pk_fma_f32 v[22:23], v[6:7], v[22:23], v[78:79] op_sel:[1,0,0] op_sel_hi:[1,1,1]
    v_max_f32 v20, 0, v20
    v_max_f32 v21, 0, v21
    v_max_f32 v22, 0, v22
    v_max_f32 v23, 0, v23
    v_pk_mul_f32 v[20:21], v[20:21], v[20:21]
    v_pk_mul_f32 v[22:23], v[22:23], v[22:23]
    v_cvt_pk_bf16_f32 v10, v20, v21
    v_cvt_pk_bf16_f32 v11, v22, v23
    buffer_store_dwordx4 v[8:11], v3, s[8:11], s30 offen offset:0 sc1
    ds_read_b128 v[72:75], v2 offset:96
    ds_read_b128 v[76:79], v2 offset:480
    s_waitcnt lgkmcnt(2)
    v_pk_fma_f32 v[24:25], v[6:7], v[64:65], v[24:25] op_sel_hi:[0,1,1] neg_lo:[1,0,0] neg_hi:[1,0,0]
    v_pk_fma_f32 v[26:27], v[6:7], v[66:67], v[26:27] op_sel_hi:[0,1,1] neg_lo:[1,0,0] neg_hi:[1,0,0]
    v_pk_fma_f32 v[24:25], v[6:7], v[24:25], v[68:69] op_sel:[1,0,0] op_sel_hi:[1,1,1]
    v_pk_fma_f32 v[26:27], v[6:7], v[26:27], v[70:71] op_sel:[1,0,0] op_sel_hi:[1,1,1]
    v_max_f32 v24, 0, v24
    v_max_f32 v25, 0, v25
    v_max_f32 v26, 0, v26
    v_max_f32 v27, 0, v27
    v_pk_mul_f32 v[24:25], v[24:25], v[24:25]
    v_pk_mul_f32 v[26:27], v[26:27], v[26:27]
    v_cvt_pk_bf16_f32 v12, v24, v25
    v_cvt_pk_bf16_f32 v13, v26, v27
    ds_read_b128 v[64:67], v2 offset:128
    ds_read_b128 v[68:71], v2 offset:512
    s_waitcnt lgkmcnt(2)
    v_pk_fma_f32 v[28:29], v[6:7], v[72:73], v[28:29] op_sel_hi:[0,1,1] neg_lo:[1,0,0] neg_hi:[1,0,0]
    v_pk_fma_f32 v[30:31], v[6:7], v[74:75], v[30:31] op_sel_hi:[0,1,1] neg_lo:[1,0,0] neg_hi:[1,0,0]
    v_pk_fma_f32 v[28:29], v[6:7], v[28:29], v[76:77] op_sel:[1,0,0] op_sel_hi:[1,1,1]
    v_pk_fma_f32 v[30:31], v[6:7], v[30:31], v[78:79] op_sel:[1,0,0] op_sel_hi:[1,1,1]
    v_max_f32 v28, 0, v28
    v_max_f32 v29, 0, v29
    v_max_f32 v30, 0, v30
    v_max_f32 v31, 0, v31
    v_pk_mul_f32 v[28:29], v[28:29], v[28:29]
    v_pk_mul_f32 v[30:31], v[30:31], v[30:31]
    v_cvt_pk_bf16_f32 v14, v28, v29
    v_cvt_pk_bf16_f32 v15, v30, v31
    buffer_store_dwordx4 v[12:15], v3, s[8:11], s30 offen offset:1024 sc1
    s_cmp_eq_u32 s29, 14
    s_cbranch_scc1 L_skipft_90
    ds_read_b128 v[72:75], v2 offset:160
    ds_read_b128 v[76:79], v2 offset:544
    s_waitcnt lgkmcnt(2)
    v_pk_fma_f32 v[32:33], v[6:7], v[64:65], v[32:33] op_sel_hi:[0,1,1] neg_lo:[1,0,0] neg_hi:[1,0,0]
    v_pk_fma_f32 v[34:35], v[6:7], v[66:67], v[34:35] op_sel_hi:[0,1,1] neg_lo:[1,0,0] neg_hi:[1,0,0]
    v_pk_fma_f32 v[32:33], v[6:7], v[32:33], v[68:69] op_sel:[1,0,0] op_sel_hi:[1,1,1]
    v_pk_fma_f32 v[34:35], v[6:7], v[34:35], v[70:71] op_sel:[1,0,0] op_sel_hi:[1,1,1]
    v_max_f32 v32, 0, v32
    v_max_f32 v33, 0, v33
    v_max_f32 v34, 0, v34
    v_max_f32 v35, 0, v35
    v_pk_mul_f32 v[32:33], v[32:33], v[32:33]
    v_pk_mul_f32 v[34:35], v[34:35], v[34:35]
    v_cvt_pk_bf16_f32 v8, v32, v33
    v_cvt_pk_bf16_f32 v9, v34, v35
    ds_read_b128 v[64:67], v2 offset:192
    ds_read_b128 v[68:71], v2 offset:576
    s_waitcnt lgkmcnt(2)
    v_pk_fma_f32 v[36:37], v[6:7], v[72:73], v[36:37] op_sel_hi:[0,1,1] neg_lo:[1,0,0] neg_hi:[1,0,0]
    v_pk_fma_f32 v[38:39], v[6:7], v[74:75], v[38:39] op_sel_hi:[0,1,1] neg_lo:[1,0,0] neg_hi:[1,0,0]
    v_pk_fma_f32 v[36:37], v[6:7], v[36:37], v[76:77] op_sel:[1,0,0] op_sel_hi:[1,1,1]
    v_pk_fma_f32 v[38:39], v[6:7], v[38:39], v[78:79] op_sel:[1,0,0] op_sel_hi:[1,1,1]
    v_max_f32 v36, 0, v36
    v_max_f32 v37, 0, v37
    v_max_f32 v38, 0, v38
    v_max_f32 v39, 0, v39
    v_pk_mul_f32 v[36:37], v[36:37], v[36:37]
    v_pk_mul_f32 v[38:39], v[38:39], v[38:39]
    v_cvt_pk_bf16_f32 v10, v36, v37
    v_cvt_pk_bf16_f32 v11, v38, v39
    buffer_store_dwordx4 v[8:11], v3, s[8:11], s30 offen offset:2048 sc1
    ds_read_b128 v[72:75], v2 offset:224
    ds_read_b128 v[76:79], v2 offset:608
    s_waitcnt lgkmcnt(2)
    v_pk_fma_f32 v[40:41], v[6:7], v[64:65], v[40:41] op_sel_hi:[0,1,1] neg_lo:[1,0,0] neg_hi:[1,0,0]
    v_pk_fma_f32 v[42:43], v[6:7], v[66:67], v[42:43] op_sel_hi:[0,1,1] neg_lo:[1,0,0] neg_hi:[1,0,0]
    v_pk_fma_f32 v[40:41], v[6:7], v[40:41], v[68:69] op_sel:[1,0,0] op_sel_hi:[1,1,1]
    v_pk_fma_f32 v[42:43], v[6:7], v[42:43], v[70:71] op_sel:[1,0,0] op_sel_hi:[1,1,1]
    v_max_f32 v40, 0, v40
    v_max_f32 v41, 0, v41
    v_max_f32 v42, 0, v42
    v_max_f32 v43, 0, v43
    v_pk_mul_f32 v[40:41], v[40:41], v[40:41]
    v_pk_mul_f32 v[42:43], v[42:43], v[42:43]
    v_cvt_pk_bf16_f32 v12, v40, v41
    v_cvt_pk_bf16_f32 v13, v42, v43
    ds_read_b128 v[64:67], v2 offset:256
    ds_read_b128 v[68:71], v2 offset:640
    s_waitcnt lgkmcnt(2)
    v_pk_fma_f32 v[44:45], v[6:7], v[72:73], v[44:45] op_sel_hi:[0,1,1] neg_lo:[1,0,0] neg_hi:[1,0,0]
    v_pk_fma_f32 v[46:47], v[6:7], v[74:75], v[46:47] op_sel_hi:[0,1,1] neg_lo:[1,0,0] neg_hi:[1,0,0]
    v_pk_fma_f32 v[44:45], v[6:7], v[44:45], v[76:77] op_sel:[1,0,0] op_sel_hi:[1,1,1]
    v_pk_fma_f32 v[46:47], v[6:7], v[46:47], v[78:79] op_sel:[1,0,0] op_sel_hi:[1,1,1]
    v_max_f32 v44, 0, v44
    v_max_f32 v45, 0, v45
    v_max_f32 v46, 0, v46
    v_max_f32 v47, 0, v47
    v_pk_mul_f32 v[44:45], v[44:45], v[44:45]
    v_pk_mul_f32 v[46:47], v[46:47], v[46:47]
    v_cvt_pk_bf16_f32 v14, v44, v45
    v_cvt_pk_bf16_f32 v15, v46, v47
    buffer_store_dwordx4 v[12:15], v3, s[8:11], s30 offen offset:3072 sc1
    ds_read_b128 v[72:75], v2 offset:288
    ds_read_b128 v[76:79], v2 offset:672
    s_waitcnt lgkmcnt(2)
    v_pk_fma_f32 v[48:49], v[6:7], v[64:65], v[48:49] op_sel_hi:[0,1,1] neg_lo:[1,0,0] neg_hi:[1,0,0]
    v_pk_fma_f32 v[50:51], v[6:7], v[66:67], v[50:51] op_sel_hi:[0,1,1] neg_lo:[1,0,0] neg_hi:[1,0,0]
    v_pk_fma_f32 v[48:49], v[6:7], v[48:49], v[68:69] op_sel:[1,0,0] op_sel_hi:[1,1,1]
    v_pk_fma_f32 v[50:51], v[6:7], v[50:51], v[70:71] op_sel:[1,0,0] op_sel_hi:[1,1,1]
    v_max_f32 v48, 0, v48
    v_max_f32 v49, 0, v49
    v_max_f32 v50, 0, v50
    v_max_f32 v51, 0, v51
    v_pk_mul_f32 v[48:49], v[48:49], v[48:49]
    v_pk_mul_f32 v[50:51], v[50:51], v[50:51]
    v_cvt_pk_bf16_f32 v8, v48, v49
    v_cvt_pk_bf16_f32 v9, v50, v51
    ds_read_b128 v[64:67], v2 offset:320
    ds_read_b128 v[68:71], v2 offset:704
    s_waitcnt lgkmcnt(2)
    v_pk_fma_f32 v[52:53], v[6:7], v[72:73], v[52:53] op_sel_hi:[0,1,1] neg_lo:[1,0,0] neg_hi:[1,0,0]
    v_pk_fma_f32 v[54:55], v[6:7], v[74:75], v[54:55] op_sel_hi:[0,1,1] neg_lo:[1,0,0] neg_hi:[1,0,0]
    v_pk_fma_f32 v[52:53], v[6:7], v[52:53], v[76:77] op_sel:[1,0,0] op_sel_hi:[1,1,1]
    v_pk_fma_f32 v[54:55], v[6:7], v[54:55], v[78:79] op_sel:[1,0,0] op_sel_hi:[1,1,1]
    v_max_f32 v52, 0, v52
    v_max_f32 v53, 0, v53
    v_max_f32 v54, 0, v54
    v_max_f32 v55, 0, v55
    v_pk_mul_f32 v[52:53], v[52:53], v[52:53]
    v_pk_mul_f32 v[54:55], v[54:55], v[54:55]
    v_cvt_pk_bf16_f32 v10, v52, v53
    v_cvt_pk_bf16_f32 v11, v54, v55
    s_add_u32 s31, s30, 4096
    buffer_store_dwordx4 v[8:11], v3, s[8:11], s31 offen offset:0 sc1
    ds_read_b128 v[72:75], v2 offset:352
    ds_read_b128 v[76:79], v2 offset:736
    s_waitcnt lgkmcnt(2)
    v_pk_fma_f32 v[56:57], v[6:7], v[64:65], v[56:57] op_sel_hi:[0,1,1] neg_lo:[1,0,0] neg_hi:[1,0,0]
    v_pk_fma_f32 v[58:59], v[6:7], v[66:67], v[58:59] op_sel_hi:[0,1,1] neg_lo:[1,0,0] neg_hi:[1,0,0]
    v_pk_fma_f32 v[56:57], v[6:7], v[56:57], v[68:69] op_sel:[1,0,0] op_sel_hi:[1,1,1]
    v_pk_fma_f32 v[58:59], v[6:7], v[58:59], v[70:71] op_sel:[1,0,0] op_sel_hi:[1,1,1]
    v_max_f32 v56, 0, v56
    v_max_f32 v57, 0, v57
    v_max_f32 v58, 0, v58
    v_max_f32 v59, 0, v59
    v_pk_mul_f32 v[56:57], v[56:57], v[56:57]
    v_pk_mul_f32 v[58:59], v[58:59], v[58:59]
    v_cvt_pk_bf16_f32 v12, v56, v57
    v_cvt_pk_bf16_f32 v13, v58, v59
    s_waitcnt lgkmcnt(0)
    v_pk_fma_f32 v[60:61], v[6:7], v[72:73], v[60:61] op_sel_hi:[0,1,1] neg_lo:[1,0,0] neg_hi:[1,0,0]
    v_pk_fma_f32 v[62:63], v[6:7], v[74:75], v[62:63] op_sel_hi:[0,1,1] neg_lo:[1,0,0] neg_hi:[1,0,0]
    v_pk_fma_f32 v[60:61], v[6:7], v[60:61], v[76:77] op_sel:[1,0,0] op_sel_hi:[1,1,1]
    v_pk_fma_f32 v[62:63], v[6:7], v[62:63], v[78:79] op_sel:[1,0,0] op_sel_hi:[1,1,1]
    v_max_f32 v60, 0, v60
    v_max_f32 v61, 0, v61
    v_max_f32 v62, 0, v62
    v_max_f32 v63, 0, v63
    v_pk_mul_f32 v[60:61], v[60:61], v[60:61]
    v_pk_mul_f32 v[62:63], v[62:63], v[62:63]
    v_cvt_pk_bf16_f32 v14, v60, v61
    v_cvt_pk_bf16_f32 v15, v62, v63
    s_add_u32 s31, s30, 4096
    buffer_store_dwordx4 v[12:15], v3, s[8:11], s31 offen offset:1024 sc1
L_skipft_90:
    s_waitcnt lgkmcnt(0)
    s_branch L_M_P3_done
L_m3idle_79:
    s_barrier
    s_barrier
    s_barrier
    s_barrier
    s_barrier
    s_barrier
    s_barrier
    s_barrier
    s_barrier
    s_barrier
    s_barrier
    s_barrier
    s_barrier
    s_barrier
    s_barrier
    s_barrier
L_M_P3_done:
    s_lshr_b32 s74, s7, 2
    s_and_b32 s75, s3, 1
    s_lshr_b32 s76, s3, 1
    s_lshl_b32 s74, s74, 1
    s_add_u32 s74, s74, s75
    s_mul_i32 s74, s74, 86
    s_mul_i32 s76, s76, 43
    s_add_u32 s74, s74, s76
    s_add_u32 s74, s74, 8
    s_lshl_b32 s74, s74, 10
    s_add_u32 s74, s74, 7340032
    v_lshlrev_b32 v252, 4, v1
    buffer_load_dwordx4 v[112:115], v252, s[8:11], s74 offen offset:0
    buffer_load_dwordx4 v[116:119], v252, s[8:11], s74 offen offset:1024
    buffer_load_dwordx4 v[120:123], v252, s[8:11], s74 offen offset:2048
    buffer_load_dwordx4 v[124:127], v252, s[8:11], s74 offen offset:3072
    s_add_u32 s74, s74, 4096
    buffer_load_dwordx4 v[128:131], v252, s[8:11], s74 offen offset:0
    buffer_load_dwordx4 v[132:135], v252, s[8:11], s74 offen offset:1024
    buffer_load_dwordx4 v[136:139], v252, s[8:11], s74 offen offset:2048
    buffer_load_dwordx4 v[140:143], v252, s[8:11], s74 offen offset:3072
    s_waitcnt vmcnt(8)
    v_mov_b32 v7, 1
    v_mov_b32 v8, 156436
    s_waitcnt lgkmcnt(0)
    s_mov_b64 exec, 1
    ds_add_rtn_u32 v9, v8, v7
    s_mov_b64 exec, -1
    s_waitcnt lgkmcnt(0)
    v_readfirstlane_b32 s30, v9
    s_cmp_eq_u32 s30, 3
    s_cbranch_scc0 L_nof3_91
    s_lshl_b32 s30, s2, 4
    s_add_u32 s30, s30, 8192
    v_mov_b32 v2, s4
    v_mov_b32 v3, 0
    s_mov_b64 exec, 1
    buffer_store_dword v2, v3, s[8:11], s30 offen sc1
    s_mov_b64 exec, -1
L_nof3_91:
    s_lshr_b32 s74, s7, 2
    s_and_b32 s75, s3, 1
    s_lshr_b32 s76, s3, 1
    s_lshl_b32 s74, s74, 1
    s_add_u32 s74, s74, s75
    s_mul_i32 s74, s74, 86
    s_mul_i32 s76, s76, 43
    s_add_u32 s74, s74, s76
    s_add_u32 s74, s74, 0
    s_lshl_b32 s74, s74, 10
    s_add_u32 s74, s74, 7340032
    v_lshlrev_b32 v252, 4, v1
    buffer_load_dwordx4 v[80:83], v252, s[8:11], s74 offen offset:0
    buffer_load_dwordx4 v[84:87], v252, s[8:11], s74 offen offset:1024
    buffer_load_dwordx4 v[88:91], v252, s[8:11], s74 offen offset:2048
    buffer_load_dwordx4 v[92:95], v252, s[8:11], s74 offen offset:3072
    s_add_u32 s74, s74, 4096
    buffer_load_dwordx4 v[96:99], v252, s[8:11], s74 offen offset:0
    buffer_load_dwordx4 v[100:103], v252, s[8:11], s74 offen offset:1024
    buffer_load_dwordx4 v[104:107], v252, s[8:11], s74 offen offset:2048
    buffer_load_dwordx4 v[108:111], v252, s[8:11], s74 offen offset:3072
    s_and_b32 s28, s7, 3
    s_lshl_b32 s29, s6, 2
    s_add_u32 s28, s28, s29
    s_lshr_b32 s29, s7, 2
    s_and_b32 s30, s3, 1
    s_lshr_b32 s31, s3, 1
    s_lshl_b32 s32, s29, 1
    s_add_u32 s32, s32, s30
    v_lshlrev_b32 v2, 4, v1
    v_and_b32 v3, 31, v1
    v_lshrrev_b32 v4, 5, v1
    s_lshl_b32 s33, s32, 5
    s_lshl_b32 s34, s28, 6
    s_lshl_b32 s35, s31, 5
    s_add_u32 s34, s34, s35
    v_lshlrev_b32 v5, 2, v4
    v_add_u32 v6, s33, v5
    s_nop 0
    s_waitcnt vmcnt(0)
    v_mov_b32 v11, 1
    v_mov_b32 v12, 156464
    s_waitcnt lgkmcnt(0)
    s_mov_b64 exec, 1
    ds_add_u32 v12, v11
    s_mov_b64 exec, -1
    s_barrier
    s_lshl_b32 s35, s31, 11
    v_add_u32 v9, s35, v2
    v_add_u32 v10, 0x10000, v9
    v_add_u32 v13, 0x20000, v9
    s_barrier
    ds_read_b128 v[48:51], v9 offset:0
    ds_read_b128 v[52:55], v9 offset:1024
    ds_read_b128 v[56:59], v9 offset:4096
    ds_read_b128 v[60:63], v9 offset:5120
    s_waitcnt lgkmcnt(2)
    v_mfma_f32_32x32x16_bf16 v[16:31], v[144:147], v[48:51], 0
    v_mfma_f32_32x32x16_bf16 v[32:47], v[144:147], v[52:55], 0
    ds_read_b128 v[48:51], v9 offset:8192
    ds_read_b128 v[52:55], v9 offset:9216
    s_waitcnt lgkmcnt(2)
    v_mfma_f32_32x32x16_bf16 v[16:31], v[148:151], v[56:59], v[16:31]
    v_mfma_f32_32x32x16_bf16 v[32:47], v[148:151], v[60:63], v[32:47]
    ds_read_b128 v[56:59], v9 offset:12288
    ds_read_b128 v[60:63], v9 offset:13312
    s_waitcnt lgkmcnt(2)
    v_mfma_f32_32x32x16_bf16 v[16:31], v[152:155], v[48:51], v[16:31]
    v_mfma_f32_32x32x16_bf16 v[32:47], v[152:155], v[52:55], v[32:47]
    s_barrier
    ds_read_b128 v[48:51], v9 offset:16384
    ds_read_b128 v[52:55], v9 offset:17408
    s_waitcnt lgkmcnt(2)
    v_mfma_f32_32x32x16_bf16 v[16:31], v[156:159], v[56:59], v[16:31]
    v_mfma_f32_32x32x16_bf16 v[32:47], v[156:159], v[60:63], v[32:47]
    ds_read_b128 v[56:59], v9 offset:20480
    ds_read_b128 v[60:63], v9 offset:21504
    s_waitcnt lgkmcnt(2)
    v_mfma_f32_32x32x16_bf16 v[16:31], v[160:163], v[48:51], v[16:31]
    v_mfma_f32_32x32x16_bf16 v[32:47], v[160:163], v[52:55], v[32:47]
    ds_read_b128 v[48:51], v9 offset:24576
    ds_read_b128 v[52:55], v9 offset:25600
    s_waitcnt lgkmcnt(2)
    v_mfma_f32_32x32x16_bf16 v[16:31], v[164:167], v[56:59], v[16:31]
    v_mfma_f32_32x32x16_bf16 v[32:47], v[164:167], v[60:63], v[32:47]
    ds_read_b128 v[56:59], v9 offset:28672
    ds_read_b128 v[60:63], v9 offset:29696
    s_waitcnt lgkmcnt(2)
    v_mfma_f32_32x32x16_bf16 v[16:31], v[168:171], v[48:51], v[16:31]
    v_mfma_f32_32x32x16_bf16 v[32:47], v[168:171], v[52:55], v[32:47]
    s_barrier
    ds_read_b128 v[48:51], v9 offset:32768
    ds_read_b128 v[52:55], v9 offset:33792
    s_waitcnt lgkmcnt(2)
    v_mfma_f32_32x32x16_bf16 v[16:31], v[172:175], v[56:59], v[16:31]
    v_mfma_f32_32x32x16_bf16 v[32:47], v[172:175], v[60:63], v[32:47]
    ds_read_b128 v[56:59], v9 offset:36864
    ds_read_b128 v[60:63], v9 offset:37888
    s_waitcnt lgkmcnt(2)
    v_mfma_f32_32x32x16_bf16 v[16:31], v[176:179], v[48:51], v[16:31]
    v_mfma_f32_32x32x16_bf16 v[32:47], v[176:179], v[52:55], v[32:47]
    ds_read_b128 v[48:51], v9 offset:40960
    ds_read_b128 v[52:55], v9 offset:41984
    s_waitcnt lgkmcnt(2)
    v_mfma_f32_32x32x16_bf16 v[16:31], v[180:183], v[56:59], v[16:31]
    v_mfma_f32_32x32x16_bf16 v[32:47], v[180:183], v[60:63], v[32:47]
    ds_read_b128 v[56:59], v9 offset:45056
    ds_read_b128 v[60:63], v9 offset:46080
    s_waitcnt lgkmcnt(2)
    v_mfma_f32_32x32x16_bf16 v[16:31], v[184:187], v[48:51], v[16:31]
    v_mfma_f32_32x32x16_bf16 v[32:47], v[184:187], v[52:55], v[32:47]
    s_barrier
    ds_read_b128 v[48:51], v9 offset:49152
    ds_read_b128 v[52:55], v9 offset:50176
    s_waitcnt lgkmcnt(2)
    v_mfma_f32_32x32x16_bf16 v[16:31], v[188:191], v[56:59], v[16:31]
    v_mfma_f32_32x32x16_bf16 v[32:47], v[188:191], v[60:63], v[32:47]
    ds_read_b128 v[56:59], v9 offset:53248
    ds_read_b128 v[60:63], v9 offset:54272
    s_waitcnt lgkmcnt(2)
    v_mfma_f32_32x32x16_bf16 v[16:31], v[192:195], v[48:51], v[16:31]
    v_mfma_f32_32x32x16_bf16 v[32:47], v[192:195], v[52:55], v[32:47]
    ds_read_b128 v[48:51], v9 offset:57344
    ds_read_b128 v[52:55], v9 offset:58368
    s_waitcnt lgkmcnt(2)
    v_mfma_f32_32x32x16_bf16 v[16:31], v[196:199], v[56:59], v[16:31]
    v_mfma_f32_32x32x16_bf16 v[32:47], v[196:199], v[60:63], v[32:47]
    ds_read_b128 v[56:59], v9 offset:61440
    ds_read_b128 v[60:63], v9 offset:62464
    s_waitcnt lgkmcnt(2)
    v_mfma_f32_32x32x16_bf16 v[16:31], v[200:203], v[48:51], v[16:31]
    v_mfma_f32_32x32x16_bf16 v[32:47], v[200:203], v[52:55], v[32:47]
    s_barrier
    ds_read_b128 v[48:51], v10 offset:0
    ds_read_b128 v[52:55], v10 offset:1024
    s_waitcnt lgkmcnt(2)
    v_mfma_f32_32x32x16_bf16 v[16:31], v[204:207], v[56:59], v[16:31]
    v_mfma_f32_32x32x16_bf16 v[32:47], v[204:207], v[60:63], v[32:47]
    ds_read_b128 v[56:59], v10 offset:4096
    ds_read_b128 v[60:63], v10 offset:5120
    s_waitcnt lgkmcnt(2)
    v_mfma_f32_32x32x16_bf16 v[16:31], v[208:211], v[48:51], v[16:31]
    v_mfma_f32_32x32x16_bf16 v[32:47], v[208:211], v[52:55], v[32:47]
    ds_read_b128 v[48:51], v10 offset:8192
    ds_read_b128 v[52:55], v10 offset:9216
    s_waitcnt lgkmcnt(2)
    v_mfma_f32_32x32x16_bf16 v[16:31], v[212:215], v[56:59], v[16:31]
    v_mfma_f32_32x32x16_bf16 v[32:47], v[212:215], v[60:63], v[32:47]
    ds_read_b128 v[56:59], v10 offset:12288
    ds_read_b128 v[60:63], v10 offset:13312
    s_waitcnt lgkmcnt(2)
    v_mfma_f32_32x32x16_bf16 v[16:31], v[216:219], v[48:51], v[16:31]
    v_mfma_f32_32x32x16_bf16 v[32:47], v[216:219], v[52:55], v[32:47]
    s_barrier
    ds_read_b128 v[48:51], v10 offset:16384
    ds_read_b128 v[52:55], v10 offset:17408
    s_waitcnt lgkmcnt(2)
    v_mfma_f32_32x32x16_bf16 v[16:31], v[220:223], v[56:59], v[16:31]
    v_mfma_f32_32x32x16_bf16 v[32:47], v[220:223], v[60:63], v[32:47]
    ds_read_b128 v[56:59], v10 offset:20480
    ds_read_b128 v[60:63], v10 offset:21504
    s_waitcnt lgkmcnt(2)
    v_mfma_f32_32x32x16_bf16 v[16:31], v[224:227], v[48:51], v[16:31]
    v_mfma_f32_32x32x16_bf16 v[32:47], v[224:227], v[52:55], v[32:47]
    ds_read_b128 v[48:51], v10 offset:24576
    ds_read_b128 v[52:55], v10 offset:25600
    s_waitcnt lgkmcnt(2)
    v_mfma_f32_32x32x16_bf16 v[16:31], v[228:231], v[56:59], v[16:31]
    v_mfma_f32_32x32x16_bf16 v[32:47], v[228:231], v[60:63], v[32:47]
    ds_read_b128 v[56:59], v10 offset:28672
    ds_read_b128 v[60:63], v10 offset:29696
    s_waitcnt lgkmcnt(2)
    v_mfma_f32_32x32x16_bf16 v[16:31], v[232:235], v[48:51], v[16:31]
    v_mfma_f32_32x32x16_bf16 v[32:47], v[232:235], v[52:55], v[32:47]
    s_barrier
    ds_read_b128 v[48:51], v10 offset:32768
    ds_read_b128 v[52:55], v10 offset:33792
    s_waitcnt lgkmcnt(2)
    v_mfma_f32_32x32x16_bf16 v[16:31], v[236:239], v[56:59], v[16:31]
    v_mfma_f32_32x32x16_bf16 v[32:47], v[236:239], v[60:63], v[32:47]
    ds_read_b128 v[56:59], v10 offset:36864
    ds_read_b128 v[60:63], v10 offset:37888
    s_waitcnt lgkmcnt(2)
    v_mfma_f32_32x32x16_bf16 v[16:31], v[240:243], v[48:51], v[16:31]
    v_mfma_f32_32x32x16_bf16 v[32:47], v[240:243], v[52:55], v[32:47]
    ds_read_b128 v[48:51], v10 offset:40960
    ds_read_b128 v[52:55], v10 offset:41984
    s_waitcnt lgkmcnt(2)
    v_mfma_f32_32x32x16_bf16 v[16:31], v[244:247], v[56:59], v[16:31]
    v_mfma_f32_32x32x16_bf16 v[32:47], v[244:247], v[60:63], v[32:47]
    ds_read_b128 v[56:59], v10 offset:45056
    ds_read_b128 v[60:63], v10 offset:46080
    s_waitcnt lgkmcnt(2)
    v_mfma_f32_32x32x16_bf16 v[16:31], v[248:251], v[48:51], v[16:31]
    v_mfma_f32_32x32x16_bf16 v[32:47], v[248:251], v[52:55], v[32:47]
    s_barrier
    ds_read_b128 v[48:51], v10 offset:49152
    ds_read_b128 v[52:55], v10 offset:50176
    s_waitcnt lgkmcnt(2)
    v_mfma_f32_32x32x16_bf16 v[16:31], v[80:83], v[56:59], v[16:31]
    v_mfma_f32_32x32x16_bf16 v[32:47], v[80:83], v[60:63], v[32:47]
    ds_read_b128 v[56:59], v10 offset:53248
    ds_read_b128 v[60:63], v10 offset:54272
    s_waitcnt lgkmcnt(2)
    v_mfma_f32_32x32x16_bf16 v[16:31], v[84:87], v[48:51], v[16:31]
    v_mfma_f32_32x32x16_bf16 v[32:47], v[84:87], v[52:55], v[32:47]
    ds_read_b128 v[48:51], v10 offset:57344
    ds_read_b128 v[52:55], v10 offset:58368
    s_waitcnt lgkmcnt(2)
    v_mfma_f32_32x32x16_bf16 v[16:31], v[88:91], v[56:59], v[16:31]
    v_mfma_f32_32x32x16_bf16 v[32:47], v[88:91], v[60:63], v[32:47]
    ds_read_b128 v[56:59], v10 offset:61440
    ds_read_b128 v[60:63], v10 offset:62464
    s_waitcnt lgkmcnt(2)
    v_mfma_f32_32x32x16_bf16 v[16:31], v[92:95], v[48:51], v[16:31]
    v_mfma_f32_32x32x16_bf16 v[32:47], v[92:95], v[52:55], v[32:47]
    s_mov_b32 s16, s62
    s_and_b32 s17, s63, 0xffff
    s_mov_b32 s18, 1024
    s_mov_b32 s19, 0x20000
    s_mov_b32 s12, s68
    s_and_b32 s13, s69, 0xffff
    s_mov_b32 s14, 2097152
    s_mov_b32 s15, 0x20000
    v_lshlrev_b32 v11, 2, v6
    s_mov_b32 s35, 528384
    v_lshlrev_b32 v12, 1, v6
    buffer_load_dwordx4 v[152:155], v11, s[8:11], s35 offen offset:0
    buffer_load_dwordx2 v[144:145], v12, s[16:19], 0 offen offset:0
    buffer_load_dwordx4 v[156:159], v11, s[8:11], s35 offen offset:32
    buffer_load_dwordx2 v[146:147], v12, s[16:19], 0 offen offset:16
    buffer_load_dwordx4 v[160:163], v11, s[8:11], s35 offen offset:64
    buffer_load_dwordx2 v[148:149], v12, s[16:19], 0 offen offset:32
    buffer_load_dwordx4 v[164:167], v11, s[8:11], s35 offen offset:96
    buffer_load_dwordx2 v[150:151], v12, s[16:19], 0 offen offset:48
    s_barrier
    ds_read_b128 v[48:51], v13 offset:0
    ds_read_b128 v[52:55], v13 offset:1024
    s_waitcnt lgkmcnt(2)
    v_mfma_f32_32x32x16_bf16 v[16:31], v[96:99], v[56:59], v[16:31]
    v_mfma_f32_32x32x16_bf16 v[32:47], v[96:99], v[60:63], v[32:47]
    ds_read_b128 v[56:59], v13 offset:4096
    ds_read_b128 v[60:63], v13 offset:5120
    s_waitcnt lgkmcnt(2)
    v_mfma_f32_32x32x16_bf16 v[16:31], v[100:103], v[48:51], v[16:31]
    v_mfma_f32_32x32x16_bf16 v[32:47], v[100:103], v[52:55], v[32:47]
    ds_read_b128 v[48:51], v9 offset:0
    ds_read_b128 v[52:55], v9 offset:1024
    s_waitcnt lgkmcnt(2)
    v_mfma_f32_32x32x16_bf16 v[16:31], v[104:107], v[56:59], v[16:31]
    v_mfma_f32_32x32x16_bf16 v[32:47], v[104:107], v[60:63], v[32:47]
    ds_read_b128 v[56:59], v9 offset:4096
    ds_read_b128 v[60:63], v9 offset:5120
    s_waitcnt lgkmcnt(2)
    v_mfma_f32_32x32x16_bf16 v[16:31], v[108:111], v[48:51], v[16:31]
    v_mfma_f32_32x32x16_bf16 v[32:47], v[108:111], v[52:55], v[32:47]
    s_barrier
    ds_read_b128 v[48:51], v9 offset:8192
    ds_read_b128 v[52:55], v9 offset:9216
    s_waitcnt lgkmcnt(2)
    v_mfma_f32_32x32x16_bf16 v[16:31], v[112:115], v[56:59], v[16:31]
    v_mfma_f32_32x32x16_bf16 v[32:47], v[112:115], v[60:63], v[32:47]
    ds_read_b128 v[56:59], v9 offset:12288
    ds_read_b128 v[60:63], v9 offset:13312
    s_waitcnt lgkmcnt(2)
    v_mfma_f32_32x32x16_bf16 v[16:31], v[116:119], v[48:51], v[16:31]
    v_mfma_f32_32x32x16_bf16 v[32:47], v[116:119], v[52:55], v[32:47]
    ds_read_b128 v[48:51], v9 offset:16384
    ds_read_b128 v[52:55], v9 offset:17408
    s_waitcnt lgkmcnt(2)
    v_mfma_f32_32x32x16_bf16 v[16:31], v[120:123], v[56:59], v[16:31]
    v_mfma_f32_32x32x16_bf16 v[32:47], v[120:123], v[60:63], v[32:47]
    ds_read_b128 v[56:59], v9 offset:20480
    ds_read_b128 v[60:63], v9 offset:21504
    s_waitcnt lgkmcnt(2)
    v_mfma_f32_32x32x16_bf16 v[16:31], v[124:127], v[48:51], v[16:31]
    v_mfma_f32_32x32x16_bf16 v[32:47], v[124:127], v[52:55], v[32:47]
    s_barrier
    ds_read_b128 v[48:51], v9 offset:24576
    ds_read_b128 v[52:55], v9 offset:25600
    s_waitcnt lgkmcnt(2)
    v_mfma_f32_32x32x16_bf16 v[16:31], v[128:131], v[56:59], v[16:31]
    v_mfma_f32_32x32x16_bf16 v[32:47], v[128:131], v[60:63], v[32:47]
    ds_read_b128 v[56:59], v9 offset:28672
    ds_read_b128 v[60:63], v9 offset:29696
    s_waitcnt lgkmcnt(2)
    v_mfma_f32_32x32x16_bf16 v[16:31], v[132:135], v[48:51], v[16:31]
    v_mfma_f32_32x32x16_bf16 v[32:47], v[132:135], v[52:55], v[32:47]
    ds_read_b128 v[48:51], v9 offset:32768
    ds_read_b128 v[52:55], v9 offset:33792
    s_waitcnt lgkmcnt(2)
    v_mfma_f32_32x32x16_bf16 v[16:31], v[136:139], v[56:59], v[16:31]
    v_mfma_f32_32x32x16_bf16 v[32:47], v[136:139], v[60:63], v[32:47]
    s_waitcnt lgkmcnt(0)
    v_mfma_f32_32x32x16_bf16 v[16:31], v[140:143], v[48:51], v[16:31]
    v_mfma_f32_32x32x16_bf16 v[32:47], v[140:143], v[52:55], v[32:47]
    s_lshl_b32 s35, s3, 12
    s_add_u32 s35, s35, 147456
    v_add_u32 v4, s35, v2
    s_xor_b32 s35, s3, 2
    s_lshl_b32 s35, s35, 12
    s_add_u32 s35, s35, 147456
    v_add_u32 v5, s35, v2
    s_and_b32 s35, s3, 1
    s_lshl_b32 s35, s35, 5
    v_lshrrev_b32 v7, 5, v1
    v_lshlrev_b32 v7, 2, v7
    v_add_u32 v7, s35, v7
    v_lshlrev_b32 v7, 7, v7
    s_lshl_b32 s35, s31, 6
    v_lshlrev_b32 v8, 1, v3
    v_add3_u32 v7, v7, v8, s35
    v_add_u32 v7, 139264, v7
    s_cmp_eq_u32 s31, 0
    s_cbranch_scc0 L_kh1_92
    ds_write_b128 v4, v[32:35] offset:0
    ds_write_b128 v4, v[36:39] offset:1024
    ds_write_b128 v4, v[40:43] offset:2048
    ds_write_b128 v4, v[44:47] offset:3072
    s_branch L_khj_93
L_kh1_92:
    ds_write_b128 v4, v[16:19] offset:0
    ds_write_b128 v4, v[20:23] offset:1024
    ds_write_b128 v4, v[24:27] offset:2048
    ds_write_b128 v4, v[28:31] offset:3072
    v_mov_b32 v16, v32
    v_mov_b32 v17, v33
    v_mov_b32 v18, v34
    v_mov_b32 v19, v35
    v_mov_b32 v20, v36
    v_mov_b32 v21, v37
    v_mov_b32 v22, v38
    v_mov_b32 v23, v39
    v_mov_b32 v24, v40
    v_mov_b32 v25, v41
    v_mov_b32 v26, v42
    v_mov_b32 v27, v43
    v_mov_b32 v28, v44
    v_mov_b32 v29, v45
    v_mov_b32 v30, v46
    v_mov_b32 v31, v47
L_khj_93:
    ds_read_u16 v80, v7 offset:0
    ds_read_u16 v81, v7 offset:128
    ds_read_u16 v82, v7 offset:256
    ds_read_u16 v83, v7 offset:384
    ds_read_u16 v84, v7 offset:1024
    ds_read_u16 v85, v7 offset:1152
    ds_read_u16 v86, v7 offset:1280
    ds_read_u16 v87, v7 offset:1408
    s_waitcnt vmcnt(0)
    v_lshlrev_b32 v96, 16, v144
    v_and_b32 v97, 0xffff0000, v144
    v_lshlrev_b32 v98, 16, v145
    v_and_b32 v99, 0xffff0000, v145
    v_lshlrev_b32 v100, 16, v146
    v_and_b32 v101, 0xffff0000, v146
    v_lshlrev_b32 v102, 16, v147
    v_and_b32 v103, 0xffff0000, v147
    v_lshlrev_b32 v104, 16, v148
    v_and_b32 v105, 0xffff0000, v148
    v_lshlrev_b32 v106, 16, v149
    v_and_b32 v107, 0xffff0000, v149
    v_lshlrev_b32 v108, 16, v150
    v_and_b32 v109, 0xffff0000, v150
    v_lshlrev_b32 v110, 16, v151
    v_and_b32 v111, 0xffff0000, v151
    s_waitcnt lgkmcnt(8)
    s_barrier
    ds_read_b128 v[48:51], v5 offset:0
    ds_read_b128 v[52:55], v5 offset:1024
    ds_read_b128 v[56:59], v5 offset:2048
    ds_read_b128 v[60:63], v5 offset:3072
    ds_read_u16 v88, v7 offset:2048
    ds_read_u16 v89, v7 offset:2176
    ds_read_u16 v90, v7 offset:2304
    ds_read_u16 v91, v7 offset:2432
    ds_read_u16 v92, v7 offset:3072
    ds_read_u16 v93, v7 offset:3200
    ds_read_u16 v94, v7 offset:3328
    ds_read_u16 v95, v7 offset:3456
    v_pk_add_f32 v[16:17], v[16:17], v[96:97]
    v_pk_add_f32 v[18:19], v[18:19], v[98:99]
    v_pk_add_f32 v[20:21], v[20:21], v[100:101]
    v_pk_add_f32 v[22:23], v[22:23], v[102:103]
    v_pk_add_f32 v[24:25], v[24:25], v[104:105]
    v_pk_add_f32 v[26:27], v[26:27], v[106:107]
    v_pk_add_f32 v[28:29], v[28:29], v[108:109]
    v_pk_add_f32 v[30:31], v[30:31], v[110:111]
    s_waitcnt lgkmcnt(8)
    v_pk_add_f32 v[16:17], v[16:17], v[48:49]
    v_pk_add_f32 v[18:19], v[18:19], v[50:51]
    v_pk_add_f32 v[20:21], v[20:21], v[52:53]
    v_pk_add_f32 v[22:23], v[22:23], v[54:55]
    v_pk_add_f32 v[24:25], v[24:25], v[56:57]
    v_pk_add_f32 v[26:27], v[26:27], v[58:59]
    v_pk_add_f32 v[28:29], v[28:29], v[60:61]
    v_pk_add_f32 v[30:31], v[30:31], v[62:63]
    s_waitcnt lgkmcnt(0)
    v_lshlrev_b32 v80, 16, v80
    v_lshlrev_b32 v81, 16, v81
    v_lshlrev_b32 v82, 16, v82
    v_lshlrev_b32 v83, 16, v83
    v_lshlrev_b32 v84, 16, v84
    v_lshlrev_b32 v85, 16, v85
    v_lshlrev_b32 v86, 16, v86
    v_lshlrev_b32 v87, 16, v87
    v_lshlrev_b32 v88, 16, v88
    v_lshlrev_b32 v89, 16, v89
    v_lshlrev_b32 v90, 16, v90
    v_lshlrev_b32 v91, 16, v91
    v_lshlrev_b32 v92, 16, v92
    v_lshlrev_b32 v93, 16, v93
    v_lshlrev_b32 v94, 16, v94
    v_lshlrev_b32 v95, 16, v95
    v_pk_fma_f32 v[16:17], v[152:153], v[16:17], v[80:81]
    v_pk_fma_f32 v[18:19], v[154:155], v[18:19], v[82:83]
    v_pk_fma_f32 v[20:21], v[156:157], v[20:21], v[84:85]
    v_pk_fma_f32 v[22:23], v[158:159], v[22:23], v[86:87]
    v_pk_fma_f32 v[24:25], v[160:161], v[24:25], v[88:89]
    v_pk_fma_f32 v[26:27], v[162:163], v[26:27], v[90:91]
    v_pk_fma_f32 v[28:29], v[164:165], v[28:29], v[92:93]
    v_pk_fma_f32 v[30:31], v[166:167], v[30:31], v[94:95]
    v_cvt_pk_bf16_f32 v64, v16, v17
    v_cvt_pk_bf16_f32 v65, v18, v19
    v_cvt_pk_bf16_f32 v66, v20, v21
    v_cvt_pk_bf16_f32 v67, v22, v23
    v_cvt_pk_bf16_f32 v68, v24, v25
    v_cvt_pk_bf16_f32 v69, v26, v27
    v_cvt_pk_bf16_f32 v70, v28, v29
    v_cvt_pk_bf16_f32 v71, v30, v31
    s_nop 1
    v_permlane32_swap_b32 v64, v66
    v_permlane32_swap_b32 v65, v67
    v_permlane32_swap_b32 v68, v70
    v_permlane32_swap_b32 v69, v71
    v_add_u32 v8, s34, v3
    v_lshlrev_b32 v8, 10, v8
    v_lshrrev_b32 v4, 5, v1
    v_lshlrev_b32 v4, 4, v4
    s_lshl_b32 s35, s33, 1
    v_add3_u32 v8, v8, v4, s35
    buffer_store_dwordx4 v[64:67], v8, s[12:15], 0 offen
    buffer_store_dwordx4 v[68:71], v8, s[12:15], 0 offen offset:32
L_fin:
L_end:
    s_endpgm
L_codeend:
.section .rodata,"a"
.p2align 6
.amdhsa_kernel adaLN_cond__ssm_conv_s4__dense_activation_squared_relu__prompt_kernel
  .amdhsa_next_free_vgpr 256
  .amdhsa_next_free_sgpr 100
  .amdhsa_accum_offset 256
  .amdhsa_group_segment_fixed_size 0
  .amdhsa_kernarg_size 152
  .amdhsa_user_sgpr_count 2
  .amdhsa_user_sgpr_kernarg_segment_ptr 1
  .amdhsa_system_sgpr_workgroup_id_x 1
.end_amdhsa_kernel
```
